```python
import torch

def _softmax(x, axis=-1):
    return torch.softmax(x, dim=axis)

def _gelu(x):
    return torch.nn.functional.gelu(x, approximate='tanh')

def _silu(x):
    return torch.nn.functional.silu(x)

def _sigmoid(x):
    return torch.sigmoid(x)

def _layernorm(x, axis=-1, eps=1e-05):
    m = x.mean(dim=axis, keepdim=True)
    v = x.var(dim=axis, keepdim=True, unbiased=False)
    return (x - m) / torch.sqrt(v + eps)

def _scatter_add(tgt, idx, src, axis=0):
    return tgt.clone().index_add_(axis, idx, src)

def _segment_sum(src, seg, n):
    out = torch.zeros((n,) + src.shape[1:], dtype=src.dtype)
    return out.index_add_(0, seg, src)

def _pad(x, pw):
    flat = tuple((v for pair in reversed(pw) for v in pair))
    return torch.nn.functional.pad(x, flat)
kernel_name = 'concat_heads__sliding_block__memory_aug_recurrent_mem_tr__prompt'

def setup_inputs():

    _w = lambda a: (lambda t: t.to(torch.bfloat16) if t.is_floating_point() else t)(torch.as_tensor(a))

    def _A_setup():
        B, S, D = (1, 2048, 1024)
        return {'x': _w((lambda *s: torch.randn(*s, dtype=torch.bfloat16) * 0.2)(B, S, D)), 'wqkv': _w((lambda *s: torch.randn(*s, dtype=torch.bfloat16) * 0.2)(D, 3 * D)), 'wo': _w((lambda *s: torch.randn(*s, dtype=torch.bfloat16) * 0.05)(D, D))}
    _A_in = _A_setup()

    def _B_setup():
        B, S, Dm = (1, 2048, 1024)
        H, Dh = (32, 128)
        M, seg = (8, 32)
        seg = min(seg, S)
        S = S // seg * seg
        return {'x': _w((lambda *s: torch.randn(*s, dtype=torch.bfloat16) * 0.05)(B, S, Dm)), 'mem0': _w((lambda *s: torch.randn(*s, dtype=torch.bfloat16) * 1.6)(B, M, Dm)), 'Wq': _w((lambda *s: torch.randn(*s, dtype=torch.bfloat16) * 0.8)(Dm, H, Dh) * Dm ** (-0.5)), 'Wk': _w((lambda *s: torch.randn(*s, dtype=torch.bfloat16) * 0.8)(Dm, H, Dh) * Dm ** (-0.5)), 'Wv': _w((lambda *s: torch.randn(*s, dtype=torch.bfloat16) * 1.6)(Dm, H, Dh) * Dm ** (-0.5)), 'Wo': _w((lambda *s: torch.randn(*s, dtype=torch.bfloat16) * 1.6)(H, Dh, Dm) * (H * Dh) ** (-0.5)), 'seg_len': seg}
    _B_in = _B_setup()
    return {'A_x': _A_in['x'], 'A_wqkv': _A_in['wqkv'], 'A_wo': _A_in['wo'], 'B_x': _B_in['x'], 'B_mem0': _B_in['mem0'], 'B_Wq': _B_in['Wq'], 'B_Wk': _B_in['Wk'], 'B_Wv': _B_in['Wv'], 'B_Wo': _B_in['Wo'], 'B_seg_len': _B_in['seg_len']}

def reference(A_x, A_wqkv, A_wo, B_x, B_mem0, B_Wq, B_Wk, B_Wv, B_Wo, B_seg_len):

    def _A_ref(x, wqkv, wo):
        B, S, D = x.shape
        H = 32
        Dh = D // H
        W = 256
        qkv = (lambda x, *d: x.permute(*d))((x @ wqkv).reshape(B, S, 3, H, Dh), 2, 0, 3, 1, 4)
        q, k, v = (qkv[0], qkv[1], qkv[2])
        scores = torch.einsum('bhqd,bhkd->bhqk', q, k) * Dh ** (-0.5)
        idx = torch.arange(S)
        mask = (idx[:, None] - idx[None, :] >= 0) & (idx[:, None] - idx[None, :] < W)
        scores = torch.where(mask[None, None], scores, -1000000000.0)
        p = _softmax(scores, axis=-1)
        o = torch.einsum('bhqk,bhkd->bhqd', p, v)
        return (lambda x, *d: x.permute(*d))(o, 0, 2, 1, 3).reshape(B, S, D) @ wo

    def _B_ref(x, mem0, Wq, Wk, Wv, Wo, seg_len):
        B, S, Dm = x.shape
        H, Dh = (Wq.shape[1], Wq.shape[2])
        M = mem0.shape[1]
        scale = Dh ** (-0.5)
        n_seg = S // seg_len
        L = M + seg_len
        idx = torch.arange(L)
        mask = (idx[:, None] < M) | (idx[:, None] >= idx[None, :])
        mem = mem0
        outs = []
        for s in range(n_seg):
            xs = x[:, s * seg_len:(s + 1) * seg_len, :].clone()
            h = torch.concatenate([mem, xs], axis=1)
            q = torch.einsum('btd,dhe->bhte', h, Wq)
            k = torch.einsum('btd,dhe->bhte', h, Wk)
            v = torch.einsum('btd,dhe->bhte', h, Wv)
            scores = torch.einsum('bhqe,bhke->bhqk', q, k) * scale
            scores = torch.where(mask[None, None], scores, -1000000000.0)
            p = _softmax(scores, axis=-1)
            o = torch.einsum('bhqk,bhke->bhqe', p, v)
            o = torch.einsum('bhte,hed->btd', o, Wo)
            mem = o[:, :M, :].clone()
            outs.append(o[:, M:, :])
        return torch.concatenate(outs, axis=1)
    a = _A_ref(A_x, A_wqkv, A_wo)
    b = _B_ref(B_x, B_mem0, B_Wq, B_Wk, B_Wv, B_Wo, B_seg_len)
    return torch.concatenate([a, b], axis=-1)
```

```asm
; @launch kernel=gemm1_kernel grid=(480,1,1) block=(512,1,1) lds=131072
; @launch kernel=rec_kernel grid=(256,1,1) block=(256,1,1) lds=47104
; @launch kernel=attnA_kernel grid=(1024,1,1) block=(256,1,1) lds=25600
; @launch kernel=attnB_kernel grid=(512,1,1) block=(256,1,1) lds=52224
; @launch kernel=gemm2_kernel grid=(256,1,1) block=(256,1,1) lds=65536
.amdgcn_target "amdgcn-amd-amdhsa--gfx950"

.text
.globl gemm1_kernel
.p2align 8
.type gemm1_kernel,@function
gemm1_kernel:
    s_cmp_ge_u32 s2, 480
    s_cbranch_scc1 gemm1_kernel_end
    s_load_dwordx16 s[40:55], s[0:1], 0
    s_load_dwordx8 s[56:63], s[0:1], 64
    s_load_dwordx2 s[64:65], s[0:1], 96
    v_and_b32 v201, 63, v0
    v_lshrrev_b32 v202, 6, v0
    s_nop 1
    v_readfirstlane_b32 s3, v202
    s_waitcnt lgkmcnt(0)
    s_cmp_ge_u32 s2, 308
    s_cbranch_scc1 gemm1_kernel_noclr1
    s_mov_b32 s4, s64
    s_and_b32 s5, s65, 0xffff
    s_mov_b32 s6, 0x10000000
    s_mov_b32 s7, 0x00020000
    s_lshl_b32 s72, s2, 14
    s_add_u32 s72, s72, 100663296
    v_lshlrev_b32 v1, 4, v0
    v_mov_b32 v2, 0
    v_mov_b32 v3, 0
    v_mov_b32 v4, 0
    v_mov_b32 v5, 0
    buffer_store_dwordx4 v[2:5], v1, s[4:7], s72 offen
    s_add_u32 s72, s72, 8192
    buffer_store_dwordx4 v[2:5], v1, s[4:7], s72 offen
gemm1_kernel_noclr1:
    s_cmp_ge_u32 s2, 96
    s_cbranch_scc1 gemm1_kernel_g1b2
    s_mul_hi_u32 s72, s2, 0x15555556
    s_mul_i32 s73, s72, 12
    s_sub_u32 s73, s2, s73
    s_lshl_b32 s74, s72, 19
    s_add_u32 s20, s40, s74
    s_addc_u32 s21, s41, 0
    s_lshl_b32 s74, s73, 9
    s_add_u32 s22, s42, s74
    s_addc_u32 s23, s43, 0
    s_mul_i32 s74, s72, 1572864
    s_lshl_b32 s75, s73, 9
    s_add_u32 s74, s74, s75
    s_add_u32 s74, s74, 0
    s_add_u32 s24, s64, s74
    s_addc_u32 s25, s65, 0
    s_mov_b32 s26, 2048
    s_mov_b32 s27, 6144
    s_mov_b32 s28, 6144
    s_mov_b32 s29, 16
    s_branch gemm1_kernel_g1d3
gemm1_kernel_g1b2:
    s_sub_u32 s76, s2, 96
    s_mul_hi_u32 s72, s76, 0x5555556
    s_mul_i32 s73, s72, 48
    s_sub_u32 s73, s76, s73
    s_lshl_b32 s74, s72, 19
    s_add_u32 s20, s46, s74
    s_addc_u32 s21, s47, 0
    s_lshr_b32 s75, s73, 4
    s_and_b32 s77, s73, 15
    s_mov_b32 s22, s50
    s_mov_b32 s23, s51
    s_cmp_eq_u32 s75, 1
    s_cselect_b32 s22, s52, s22
    s_cselect_b32 s23, s53, s23
    s_cmp_eq_u32 s75, 2
    s_cselect_b32 s22, s54, s22
    s_cselect_b32 s23, s55, s23
    s_lshl_b32 s74, s77, 9
    s_add_u32 s22, s22, s74
    s_addc_u32 s23, s23, 0
    s_mul_i32 s74, s72, 6291456
    s_lshl_b32 s75, s73, 9
    s_add_u32 s74, s74, s75
    s_add_u32 s74, s74, 12582912
    s_add_u32 s24, s64, s74
    s_addc_u32 s25, s65, 0
    s_mov_b32 s26, 2048
    s_mov_b32 s27, 8192
    s_mov_b32 s28, 24576
    s_mov_b32 s29, 16
gemm1_kernel_g1d3:
    s_mov_b32 s4, s20
    s_and_b32 s5, s21, 0xffff
    s_mov_b32 s6, 0x7ffffff0
    s_mov_b32 s7, 0x00020000
    s_mov_b32 s8, s22
    s_and_b32 s9, s23, 0xffff
    s_mov_b32 s10, 0x7ffffff0
    s_mov_b32 s11, 0x00020000
    s_mov_b32 s12, s24
    s_and_b32 s13, s25, 0xffff
    s_mov_b32 s14, 0x7ffffff0
    s_mov_b32 s15, 0x00020000
    s_lshr_b32 s30, s3, 1
    s_and_b32 s31, s3, 1
    v_and_b32 v203, 15, v201
    v_lshrrev_b32 v204, 4, v201
    v_lshrrev_b32 v205, 1, v203
    s_mul_i32 s32, s30, 8192
    v_or_b32 v206, 0, v204
    v_xor_b32 v206, v206, v205
    v_lshlrev_b32 v206, 4, v206
    v_lshl_add_u32 v206, v203, 7, v206
    v_add_u32 v176, s32, v206
    v_add_u32 v178, 65536, v176
    v_or_b32 v206, 4, v204
    v_xor_b32 v206, v206, v205
    v_lshlrev_b32 v206, 4, v206
    v_lshl_add_u32 v206, v203, 7, v206
    v_add_u32 v177, s32, v206
    v_add_u32 v179, 65536, v177
    v_lshrrev_b32 v205, 2, v203
    v_and_b32 v206, 1, v204
    v_lshl_or_b32 v206, v206, 2, v205
    v_lshlrev_b32 v206, 1, v206
    v_lshl_add_u32 v205, v204, 3, v205
    s_mov_b32 s33, 512
    v_mul_lo_u32 v205, v205, s33
    v_and_b32 v203, 3, v201
    v_and_b32 v204, 1, v203
    v_lshl_add_u32 v205, v204, 3, v205
    v_add_u32 v205, 32768, v205
    v_lshrrev_b32 v203, 1, v203
    s_mul_i32 s32, s31, 16
    s_add_u32 s33, s32, 0
    v_or_b32 v204, s33, v203
    v_xor_b32 v204, v204, v206
    v_lshl_add_u32 v180, v204, 4, v205
    v_add_u32 v188, 65536, v180
    s_add_u32 s33, s32, 2
    v_or_b32 v204, s33, v203
    v_xor_b32 v204, v204, v206
    v_lshl_add_u32 v181, v204, 4, v205
    v_add_u32 v189, 65536, v181
    s_add_u32 s33, s32, 4
    v_or_b32 v204, s33, v203
    v_xor_b32 v204, v204, v206
    v_lshl_add_u32 v182, v204, 4, v205
    v_add_u32 v190, 65536, v182
    s_add_u32 s33, s32, 6
    v_or_b32 v204, s33, v203
    v_xor_b32 v204, v204, v206
    v_lshl_add_u32 v183, v204, 4, v205
    v_add_u32 v191, 65536, v183
    s_add_u32 s33, s32, 8
    v_or_b32 v204, s33, v203
    v_xor_b32 v204, v204, v206
    v_lshl_add_u32 v184, v204, 4, v205
    v_add_u32 v192, 65536, v184
    s_add_u32 s33, s32, 10
    v_or_b32 v204, s33, v203
    v_xor_b32 v204, v204, v206
    v_lshl_add_u32 v185, v204, 4, v205
    v_add_u32 v193, 65536, v185
    s_add_u32 s33, s32, 12
    v_or_b32 v204, s33, v203
    v_xor_b32 v204, v204, v206
    v_lshl_add_u32 v186, v204, 4, v205
    v_add_u32 v194, 65536, v186
    s_add_u32 s33, s32, 14
    v_or_b32 v204, s33, v203
    v_xor_b32 v204, v204, v206
    v_lshl_add_u32 v187, v204, 4, v205
    v_add_u32 v195, 65536, v187
    v_lshrrev_b32 v203, 3, v201
    v_mul_lo_u32 v203, v203, s26
    v_and_b32 v204, 7, v201
    v_lshrrev_b32 v205, 4, v201
    v_or_b32 v206, 0, v205
    v_xor_b32 v206, v206, v204
    v_lshl_add_u32 v196, v206, 4, v203
    v_or_b32 v206, 4, v205
    v_xor_b32 v206, v206, v204
    v_lshl_add_u32 v197, v206, 4, v203
    v_lshrrev_b32 v203, 5, v201
    v_and_b32 v204, 31, v201
    v_mul_lo_u32 v205, v203, s27
    s_and_b32 s33, s3, 1
    s_lshl_b32 s33, s33, 2
    s_or_b32 s33, s33, 0
    v_or_b32 v206, s33, v203
    v_lshlrev_b32 v206, 1, v206
    v_xor_b32 v206, v206, v204
    v_lshl_add_u32 v198, v206, 4, v205
    s_and_b32 s33, s3, 1
    s_lshl_b32 s33, s33, 2
    s_or_b32 s33, s33, 2
    v_or_b32 v206, s33, v203
    v_lshlrev_b32 v206, 1, v206
    v_xor_b32 v206, v206, v204
    v_lshl_add_u32 v199, v206, 4, v205
    v_and_b32 v203, 15, v201
    s_mul_i32 s32, s30, 64
    v_add_u32 v203, s32, v203
    v_mul_lo_u32 v203, v203, s28
    v_lshrrev_b32 v204, 4, v201
    s_mul_i32 s32, s31, 256
    v_lshl_add_u32 v203, v204, 3, v203
    v_add_u32 v200, s32, v203
    s_lshl_b32 s35, s26, 3
    s_mul_i32 s34, s3, 4
    s_mul_i32 s34, s34, s35
    s_mul_i32 s37, s27, 2
    s_mul_i32 s36, s3, 4
    s_mul_i32 s36, s36, s37
    s_lshl_b32 s38, s27, 6
    s_mul_i32 s66, s3, 4096
    s_mul_i32 s67, s3, 4096
    s_add_u32 s67, s67, 32768
    v_mov_b32 v0, 0
    v_mov_b32 v1, 0
    v_mov_b32 v2, 0
    v_mov_b32 v3, 0
    v_mov_b32 v4, 0
    v_mov_b32 v5, 0
    v_mov_b32 v6, 0
    v_mov_b32 v7, 0
    v_mov_b32 v8, 0
    v_mov_b32 v9, 0
    v_mov_b32 v10, 0
    v_mov_b32 v11, 0
    v_mov_b32 v12, 0
    v_mov_b32 v13, 0
    v_mov_b32 v14, 0
    v_mov_b32 v15, 0
    v_mov_b32 v16, 0
    v_mov_b32 v17, 0
    v_mov_b32 v18, 0
    v_mov_b32 v19, 0
    v_mov_b32 v20, 0
    v_mov_b32 v21, 0
    v_mov_b32 v22, 0
    v_mov_b32 v23, 0
    v_mov_b32 v24, 0
    v_mov_b32 v25, 0
    v_mov_b32 v26, 0
    v_mov_b32 v27, 0
    v_mov_b32 v28, 0
    v_mov_b32 v29, 0
    v_mov_b32 v30, 0
    v_mov_b32 v31, 0
    v_mov_b32 v32, 0
    v_mov_b32 v33, 0
    v_mov_b32 v34, 0
    v_mov_b32 v35, 0
    v_mov_b32 v36, 0
    v_mov_b32 v37, 0
    v_mov_b32 v38, 0
    v_mov_b32 v39, 0
    v_mov_b32 v40, 0
    v_mov_b32 v41, 0
    v_mov_b32 v42, 0
    v_mov_b32 v43, 0
    v_mov_b32 v44, 0
    v_mov_b32 v45, 0
    v_mov_b32 v46, 0
    v_mov_b32 v47, 0
    v_mov_b32 v48, 0
    v_mov_b32 v49, 0
    v_mov_b32 v50, 0
    v_mov_b32 v51, 0
    v_mov_b32 v52, 0
    v_mov_b32 v53, 0
    v_mov_b32 v54, 0
    v_mov_b32 v55, 0
    v_mov_b32 v56, 0
    v_mov_b32 v57, 0
    v_mov_b32 v58, 0
    v_mov_b32 v59, 0
    v_mov_b32 v60, 0
    v_mov_b32 v61, 0
    v_mov_b32 v62, 0
    v_mov_b32 v63, 0
    v_mov_b32 v64, 0
    v_mov_b32 v65, 0
    v_mov_b32 v66, 0
    v_mov_b32 v67, 0
    v_mov_b32 v68, 0
    v_mov_b32 v69, 0
    v_mov_b32 v70, 0
    v_mov_b32 v71, 0
    v_mov_b32 v72, 0
    v_mov_b32 v73, 0
    v_mov_b32 v74, 0
    v_mov_b32 v75, 0
    v_mov_b32 v76, 0
    v_mov_b32 v77, 0
    v_mov_b32 v78, 0
    v_mov_b32 v79, 0
    v_mov_b32 v80, 0
    v_mov_b32 v81, 0
    v_mov_b32 v82, 0
    v_mov_b32 v83, 0
    v_mov_b32 v84, 0
    v_mov_b32 v85, 0
    v_mov_b32 v86, 0
    v_mov_b32 v87, 0
    v_mov_b32 v88, 0
    v_mov_b32 v89, 0
    v_mov_b32 v90, 0
    v_mov_b32 v91, 0
    v_mov_b32 v92, 0
    v_mov_b32 v93, 0
    v_mov_b32 v94, 0
    v_mov_b32 v95, 0
    v_mov_b32 v96, 0
    v_mov_b32 v97, 0
    v_mov_b32 v98, 0
    v_mov_b32 v99, 0
    v_mov_b32 v100, 0
    v_mov_b32 v101, 0
    v_mov_b32 v102, 0
    v_mov_b32 v103, 0
    v_mov_b32 v104, 0
    v_mov_b32 v105, 0
    v_mov_b32 v106, 0
    v_mov_b32 v107, 0
    v_mov_b32 v108, 0
    v_mov_b32 v109, 0
    v_mov_b32 v110, 0
    v_mov_b32 v111, 0
    v_mov_b32 v112, 0
    v_mov_b32 v113, 0
    v_mov_b32 v114, 0
    v_mov_b32 v115, 0
    v_mov_b32 v116, 0
    v_mov_b32 v117, 0
    v_mov_b32 v118, 0
    v_mov_b32 v119, 0
    v_mov_b32 v120, 0
    v_mov_b32 v121, 0
    v_mov_b32 v122, 0
    v_mov_b32 v123, 0
    v_mov_b32 v124, 0
    v_mov_b32 v125, 0
    v_mov_b32 v126, 0
    v_mov_b32 v127, 0
    s_nop 4
    s_add_u32 m0, s66, 0
    s_mov_b32 s39, s34
    buffer_load_dwordx4 v196, s[4:7], s39 offen lds
    s_add_u32 m0, s66, 1024
    s_add_u32 s39, s39, s35
    buffer_load_dwordx4 v197, s[4:7], s39 offen lds
    s_add_u32 m0, s66, 2048
    s_add_u32 s39, s39, s35
    buffer_load_dwordx4 v196, s[4:7], s39 offen lds
    s_add_u32 m0, s66, 3072
    s_add_u32 s39, s39, s35
    buffer_load_dwordx4 v197, s[4:7], s39 offen lds
    s_add_u32 m0, s67, 0
    s_mov_b32 s39, s36
    buffer_load_dwordx4 v198, s[8:11], s39 offen lds
    s_add_u32 m0, s67, 1024
    s_add_u32 s39, s39, s37
    buffer_load_dwordx4 v199, s[8:11], s39 offen lds
    s_add_u32 m0, s67, 2048
    s_add_u32 s39, s39, s37
    buffer_load_dwordx4 v198, s[8:11], s39 offen lds
    s_add_u32 m0, s67, 3072
    s_add_u32 s39, s39, s37
    buffer_load_dwordx4 v199, s[8:11], s39 offen lds
    s_add_u32 s34, s34, 128
    s_add_u32 s36, s36, s38
    s_mov_b32 s70, 0
gemm1_kernel_loop4:
    s_waitcnt vmcnt(0)
    s_barrier
    s_add_u32 s71, s70, 1
    s_cmp_ge_u32 s71, s29
    s_cbranch_scc1 gemm1_kernel_skip5
    s_add_u32 m0, s66, 65536
    s_mov_b32 s39, s34
    buffer_load_dwordx4 v196, s[4:7], s39 offen lds
    s_add_u32 m0, s66, 66560
    s_add_u32 s39, s39, s35
    buffer_load_dwordx4 v197, s[4:7], s39 offen lds
    s_add_u32 m0, s66, 67584
    s_add_u32 s39, s39, s35
    buffer_load_dwordx4 v196, s[4:7], s39 offen lds
    s_add_u32 m0, s66, 68608
    s_add_u32 s39, s39, s35
    buffer_load_dwordx4 v197, s[4:7], s39 offen lds
    s_add_u32 m0, s67, 65536
    s_mov_b32 s39, s36
    buffer_load_dwordx4 v198, s[8:11], s39 offen lds
    s_add_u32 m0, s67, 66560
    s_add_u32 s39, s39, s37
    buffer_load_dwordx4 v199, s[8:11], s39 offen lds
    s_add_u32 m0, s67, 67584
    s_add_u32 s39, s39, s37
    buffer_load_dwordx4 v198, s[8:11], s39 offen lds
    s_add_u32 m0, s67, 68608
    s_add_u32 s39, s39, s37
    buffer_load_dwordx4 v199, s[8:11], s39 offen lds
    s_add_u32 s34, s34, 128
    s_add_u32 s36, s36, s38
gemm1_kernel_skip5:
    ds_read_b128 v[128:131], v176 offset:0
    ds_read_b128 v[132:135], v176 offset:2048
    ds_read_b128 v[136:139], v176 offset:4096
    ds_read_b128 v[140:143], v176 offset:6144
    ds_read_b64_tr_b16 v[144:145], v180 offset:0
    ds_read_b64_tr_b16 v[146:147], v180 offset:2048
    ds_read_b64_tr_b16 v[148:149], v181 offset:0
    ds_read_b64_tr_b16 v[150:151], v181 offset:2048
    ds_read_b64_tr_b16 v[152:153], v182 offset:0
    ds_read_b64_tr_b16 v[154:155], v182 offset:2048
    ds_read_b64_tr_b16 v[156:157], v183 offset:0
    ds_read_b64_tr_b16 v[158:159], v183 offset:2048
    ds_read_b64_tr_b16 v[160:161], v184 offset:0
    ds_read_b64_tr_b16 v[162:163], v184 offset:2048
    ds_read_b64_tr_b16 v[164:165], v185 offset:0
    ds_read_b64_tr_b16 v[166:167], v185 offset:2048
    ds_read_b64_tr_b16 v[168:169], v186 offset:0
    ds_read_b64_tr_b16 v[170:171], v186 offset:2048
    ds_read_b64_tr_b16 v[172:173], v187 offset:0
    ds_read_b64_tr_b16 v[174:175], v187 offset:2048
    s_waitcnt lgkmcnt(0)
    v_mfma_f32_16x16x32_bf16 v[0:3], v[144:147], v[128:131], v[0:3]
    v_mfma_f32_16x16x32_bf16 v[4:7], v[148:151], v[128:131], v[4:7]
    v_mfma_f32_16x16x32_bf16 v[8:11], v[152:155], v[128:131], v[8:11]
    v_mfma_f32_16x16x32_bf16 v[12:15], v[156:159], v[128:131], v[12:15]
    v_mfma_f32_16x16x32_bf16 v[16:19], v[160:163], v[128:131], v[16:19]
    v_mfma_f32_16x16x32_bf16 v[20:23], v[164:167], v[128:131], v[20:23]
    v_mfma_f32_16x16x32_bf16 v[24:27], v[168:171], v[128:131], v[24:27]
    v_mfma_f32_16x16x32_bf16 v[28:31], v[172:175], v[128:131], v[28:31]
    v_mfma_f32_16x16x32_bf16 v[32:35], v[144:147], v[132:135], v[32:35]
    v_mfma_f32_16x16x32_bf16 v[36:39], v[148:151], v[132:135], v[36:39]
    v_mfma_f32_16x16x32_bf16 v[40:43], v[152:155], v[132:135], v[40:43]
    v_mfma_f32_16x16x32_bf16 v[44:47], v[156:159], v[132:135], v[44:47]
    v_mfma_f32_16x16x32_bf16 v[48:51], v[160:163], v[132:135], v[48:51]
    v_mfma_f32_16x16x32_bf16 v[52:55], v[164:167], v[132:135], v[52:55]
    v_mfma_f32_16x16x32_bf16 v[56:59], v[168:171], v[132:135], v[56:59]
    v_mfma_f32_16x16x32_bf16 v[60:63], v[172:175], v[132:135], v[60:63]
    v_mfma_f32_16x16x32_bf16 v[64:67], v[144:147], v[136:139], v[64:67]
    v_mfma_f32_16x16x32_bf16 v[68:71], v[148:151], v[136:139], v[68:71]
    v_mfma_f32_16x16x32_bf16 v[72:75], v[152:155], v[136:139], v[72:75]
    v_mfma_f32_16x16x32_bf16 v[76:79], v[156:159], v[136:139], v[76:79]
    v_mfma_f32_16x16x32_bf16 v[80:83], v[160:163], v[136:139], v[80:83]
    v_mfma_f32_16x16x32_bf16 v[84:87], v[164:167], v[136:139], v[84:87]
    v_mfma_f32_16x16x32_bf16 v[88:91], v[168:171], v[136:139], v[88:91]
    v_mfma_f32_16x16x32_bf16 v[92:95], v[172:175], v[136:139], v[92:95]
    v_mfma_f32_16x16x32_bf16 v[96:99], v[144:147], v[140:143], v[96:99]
    v_mfma_f32_16x16x32_bf16 v[100:103], v[148:151], v[140:143], v[100:103]
    v_mfma_f32_16x16x32_bf16 v[104:107], v[152:155], v[140:143], v[104:107]
    v_mfma_f32_16x16x32_bf16 v[108:111], v[156:159], v[140:143], v[108:111]
    v_mfma_f32_16x16x32_bf16 v[112:115], v[160:163], v[140:143], v[112:115]
    v_mfma_f32_16x16x32_bf16 v[116:119], v[164:167], v[140:143], v[116:119]
    v_mfma_f32_16x16x32_bf16 v[120:123], v[168:171], v[140:143], v[120:123]
    v_mfma_f32_16x16x32_bf16 v[124:127], v[172:175], v[140:143], v[124:127]
    ds_read_b128 v[128:131], v177 offset:0
    ds_read_b128 v[132:135], v177 offset:2048
    ds_read_b128 v[136:139], v177 offset:4096
    ds_read_b128 v[140:143], v177 offset:6144
    ds_read_b64_tr_b16 v[144:145], v180 offset:16384
    ds_read_b64_tr_b16 v[146:147], v180 offset:18432
    ds_read_b64_tr_b16 v[148:149], v181 offset:16384
    ds_read_b64_tr_b16 v[150:151], v181 offset:18432
    ds_read_b64_tr_b16 v[152:153], v182 offset:16384
    ds_read_b64_tr_b16 v[154:155], v182 offset:18432
    ds_read_b64_tr_b16 v[156:157], v183 offset:16384
    ds_read_b64_tr_b16 v[158:159], v183 offset:18432
    ds_read_b64_tr_b16 v[160:161], v184 offset:16384
    ds_read_b64_tr_b16 v[162:163], v184 offset:18432
    ds_read_b64_tr_b16 v[164:165], v185 offset:16384
    ds_read_b64_tr_b16 v[166:167], v185 offset:18432
    ds_read_b64_tr_b16 v[168:169], v186 offset:16384
    ds_read_b64_tr_b16 v[170:171], v186 offset:18432
    ds_read_b64_tr_b16 v[172:173], v187 offset:16384
    ds_read_b64_tr_b16 v[174:175], v187 offset:18432
    s_waitcnt lgkmcnt(0)
    v_mfma_f32_16x16x32_bf16 v[0:3], v[144:147], v[128:131], v[0:3]
    v_mfma_f32_16x16x32_bf16 v[4:7], v[148:151], v[128:131], v[4:7]
    v_mfma_f32_16x16x32_bf16 v[8:11], v[152:155], v[128:131], v[8:11]
    v_mfma_f32_16x16x32_bf16 v[12:15], v[156:159], v[128:131], v[12:15]
    v_mfma_f32_16x16x32_bf16 v[16:19], v[160:163], v[128:131], v[16:19]
    v_mfma_f32_16x16x32_bf16 v[20:23], v[164:167], v[128:131], v[20:23]
    v_mfma_f32_16x16x32_bf16 v[24:27], v[168:171], v[128:131], v[24:27]
    v_mfma_f32_16x16x32_bf16 v[28:31], v[172:175], v[128:131], v[28:31]
    v_mfma_f32_16x16x32_bf16 v[32:35], v[144:147], v[132:135], v[32:35]
    v_mfma_f32_16x16x32_bf16 v[36:39], v[148:151], v[132:135], v[36:39]
    v_mfma_f32_16x16x32_bf16 v[40:43], v[152:155], v[132:135], v[40:43]
    v_mfma_f32_16x16x32_bf16 v[44:47], v[156:159], v[132:135], v[44:47]
    v_mfma_f32_16x16x32_bf16 v[48:51], v[160:163], v[132:135], v[48:51]
    v_mfma_f32_16x16x32_bf16 v[52:55], v[164:167], v[132:135], v[52:55]
    v_mfma_f32_16x16x32_bf16 v[56:59], v[168:171], v[132:135], v[56:59]
    v_mfma_f32_16x16x32_bf16 v[60:63], v[172:175], v[132:135], v[60:63]
    v_mfma_f32_16x16x32_bf16 v[64:67], v[144:147], v[136:139], v[64:67]
    v_mfma_f32_16x16x32_bf16 v[68:71], v[148:151], v[136:139], v[68:71]
    v_mfma_f32_16x16x32_bf16 v[72:75], v[152:155], v[136:139], v[72:75]
    v_mfma_f32_16x16x32_bf16 v[76:79], v[156:159], v[136:139], v[76:79]
    v_mfma_f32_16x16x32_bf16 v[80:83], v[160:163], v[136:139], v[80:83]
    v_mfma_f32_16x16x32_bf16 v[84:87], v[164:167], v[136:139], v[84:87]
    v_mfma_f32_16x16x32_bf16 v[88:91], v[168:171], v[136:139], v[88:91]
    v_mfma_f32_16x16x32_bf16 v[92:95], v[172:175], v[136:139], v[92:95]
    v_mfma_f32_16x16x32_bf16 v[96:99], v[144:147], v[140:143], v[96:99]
    v_mfma_f32_16x16x32_bf16 v[100:103], v[148:151], v[140:143], v[100:103]
    v_mfma_f32_16x16x32_bf16 v[104:107], v[152:155], v[140:143], v[104:107]
    v_mfma_f32_16x16x32_bf16 v[108:111], v[156:159], v[140:143], v[108:111]
    v_mfma_f32_16x16x32_bf16 v[112:115], v[160:163], v[140:143], v[112:115]
    v_mfma_f32_16x16x32_bf16 v[116:119], v[164:167], v[140:143], v[116:119]
    v_mfma_f32_16x16x32_bf16 v[120:123], v[168:171], v[140:143], v[120:123]
    v_mfma_f32_16x16x32_bf16 v[124:127], v[172:175], v[140:143], v[124:127]
    s_waitcnt vmcnt(0)
    s_barrier
    s_add_u32 s71, s70, 2
    s_cmp_ge_u32 s71, s29
    s_cbranch_scc1 gemm1_kernel_skip6
    s_add_u32 m0, s66, 0
    s_mov_b32 s39, s34
    buffer_load_dwordx4 v196, s[4:7], s39 offen lds
    s_add_u32 m0, s66, 1024
    s_add_u32 s39, s39, s35
    buffer_load_dwordx4 v197, s[4:7], s39 offen lds
    s_add_u32 m0, s66, 2048
    s_add_u32 s39, s39, s35
    buffer_load_dwordx4 v196, s[4:7], s39 offen lds
    s_add_u32 m0, s66, 3072
    s_add_u32 s39, s39, s35
    buffer_load_dwordx4 v197, s[4:7], s39 offen lds
    s_add_u32 m0, s67, 0
    s_mov_b32 s39, s36
    buffer_load_dwordx4 v198, s[8:11], s39 offen lds
    s_add_u32 m0, s67, 1024
    s_add_u32 s39, s39, s37
    buffer_load_dwordx4 v199, s[8:11], s39 offen lds
    s_add_u32 m0, s67, 2048
    s_add_u32 s39, s39, s37
    buffer_load_dwordx4 v198, s[8:11], s39 offen lds
    s_add_u32 m0, s67, 3072
    s_add_u32 s39, s39, s37
    buffer_load_dwordx4 v199, s[8:11], s39 offen lds
    s_add_u32 s34, s34, 128
    s_add_u32 s36, s36, s38
gemm1_kernel_skip6:
    ds_read_b128 v[128:131], v178 offset:0
    ds_read_b128 v[132:135], v178 offset:2048
    ds_read_b128 v[136:139], v178 offset:4096
    ds_read_b128 v[140:143], v178 offset:6144
    ds_read_b64_tr_b16 v[144:145], v188 offset:0
    ds_read_b64_tr_b16 v[146:147], v188 offset:2048
    ds_read_b64_tr_b16 v[148:149], v189 offset:0
    ds_read_b64_tr_b16 v[150:151], v189 offset:2048
    ds_read_b64_tr_b16 v[152:153], v190 offset:0
    ds_read_b64_tr_b16 v[154:155], v190 offset:2048
    ds_read_b64_tr_b16 v[156:157], v191 offset:0
    ds_read_b64_tr_b16 v[158:159], v191 offset:2048
    ds_read_b64_tr_b16 v[160:161], v192 offset:0
    ds_read_b64_tr_b16 v[162:163], v192 offset:2048
    ds_read_b64_tr_b16 v[164:165], v193 offset:0
    ds_read_b64_tr_b16 v[166:167], v193 offset:2048
    ds_read_b64_tr_b16 v[168:169], v194 offset:0
    ds_read_b64_tr_b16 v[170:171], v194 offset:2048
    ds_read_b64_tr_b16 v[172:173], v195 offset:0
    ds_read_b64_tr_b16 v[174:175], v195 offset:2048
    s_waitcnt lgkmcnt(0)
    v_mfma_f32_16x16x32_bf16 v[0:3], v[144:147], v[128:131], v[0:3]
    v_mfma_f32_16x16x32_bf16 v[4:7], v[148:151], v[128:131], v[4:7]
    v_mfma_f32_16x16x32_bf16 v[8:11], v[152:155], v[128:131], v[8:11]
    v_mfma_f32_16x16x32_bf16 v[12:15], v[156:159], v[128:131], v[12:15]
    v_mfma_f32_16x16x32_bf16 v[16:19], v[160:163], v[128:131], v[16:19]
    v_mfma_f32_16x16x32_bf16 v[20:23], v[164:167], v[128:131], v[20:23]
    v_mfma_f32_16x16x32_bf16 v[24:27], v[168:171], v[128:131], v[24:27]
    v_mfma_f32_16x16x32_bf16 v[28:31], v[172:175], v[128:131], v[28:31]
    v_mfma_f32_16x16x32_bf16 v[32:35], v[144:147], v[132:135], v[32:35]
    v_mfma_f32_16x16x32_bf16 v[36:39], v[148:151], v[132:135], v[36:39]
    v_mfma_f32_16x16x32_bf16 v[40:43], v[152:155], v[132:135], v[40:43]
    v_mfma_f32_16x16x32_bf16 v[44:47], v[156:159], v[132:135], v[44:47]
    v_mfma_f32_16x16x32_bf16 v[48:51], v[160:163], v[132:135], v[48:51]
    v_mfma_f32_16x16x32_bf16 v[52:55], v[164:167], v[132:135], v[52:55]
    v_mfma_f32_16x16x32_bf16 v[56:59], v[168:171], v[132:135], v[56:59]
    v_mfma_f32_16x16x32_bf16 v[60:63], v[172:175], v[132:135], v[60:63]
    v_mfma_f32_16x16x32_bf16 v[64:67], v[144:147], v[136:139], v[64:67]
    v_mfma_f32_16x16x32_bf16 v[68:71], v[148:151], v[136:139], v[68:71]
    v_mfma_f32_16x16x32_bf16 v[72:75], v[152:155], v[136:139], v[72:75]
    v_mfma_f32_16x16x32_bf16 v[76:79], v[156:159], v[136:139], v[76:79]
    v_mfma_f32_16x16x32_bf16 v[80:83], v[160:163], v[136:139], v[80:83]
    v_mfma_f32_16x16x32_bf16 v[84:87], v[164:167], v[136:139], v[84:87]
    v_mfma_f32_16x16x32_bf16 v[88:91], v[168:171], v[136:139], v[88:91]
    v_mfma_f32_16x16x32_bf16 v[92:95], v[172:175], v[136:139], v[92:95]
    v_mfma_f32_16x16x32_bf16 v[96:99], v[144:147], v[140:143], v[96:99]
    v_mfma_f32_16x16x32_bf16 v[100:103], v[148:151], v[140:143], v[100:103]
    v_mfma_f32_16x16x32_bf16 v[104:107], v[152:155], v[140:143], v[104:107]
    v_mfma_f32_16x16x32_bf16 v[108:111], v[156:159], v[140:143], v[108:111]
    v_mfma_f32_16x16x32_bf16 v[112:115], v[160:163], v[140:143], v[112:115]
    v_mfma_f32_16x16x32_bf16 v[116:119], v[164:167], v[140:143], v[116:119]
    v_mfma_f32_16x16x32_bf16 v[120:123], v[168:171], v[140:143], v[120:123]
    v_mfma_f32_16x16x32_bf16 v[124:127], v[172:175], v[140:143], v[124:127]
    ds_read_b128 v[128:131], v179 offset:0
    ds_read_b128 v[132:135], v179 offset:2048
    ds_read_b128 v[136:139], v179 offset:4096
    ds_read_b128 v[140:143], v179 offset:6144
    ds_read_b64_tr_b16 v[144:145], v188 offset:16384
    ds_read_b64_tr_b16 v[146:147], v188 offset:18432
    ds_read_b64_tr_b16 v[148:149], v189 offset:16384
    ds_read_b64_tr_b16 v[150:151], v189 offset:18432
    ds_read_b64_tr_b16 v[152:153], v190 offset:16384
    ds_read_b64_tr_b16 v[154:155], v190 offset:18432
    ds_read_b64_tr_b16 v[156:157], v191 offset:16384
    ds_read_b64_tr_b16 v[158:159], v191 offset:18432
    ds_read_b64_tr_b16 v[160:161], v192 offset:16384
    ds_read_b64_tr_b16 v[162:163], v192 offset:18432
    ds_read_b64_tr_b16 v[164:165], v193 offset:16384
    ds_read_b64_tr_b16 v[166:167], v193 offset:18432
    ds_read_b64_tr_b16 v[168:169], v194 offset:16384
    ds_read_b64_tr_b16 v[170:171], v194 offset:18432
    ds_read_b64_tr_b16 v[172:173], v195 offset:16384
    ds_read_b64_tr_b16 v[174:175], v195 offset:18432
    s_waitcnt lgkmcnt(0)
    v_mfma_f32_16x16x32_bf16 v[0:3], v[144:147], v[128:131], v[0:3]
    v_mfma_f32_16x16x32_bf16 v[4:7], v[148:151], v[128:131], v[4:7]
    v_mfma_f32_16x16x32_bf16 v[8:11], v[152:155], v[128:131], v[8:11]
    v_mfma_f32_16x16x32_bf16 v[12:15], v[156:159], v[128:131], v[12:15]
    v_mfma_f32_16x16x32_bf16 v[16:19], v[160:163], v[128:131], v[16:19]
    v_mfma_f32_16x16x32_bf16 v[20:23], v[164:167], v[128:131], v[20:23]
    v_mfma_f32_16x16x32_bf16 v[24:27], v[168:171], v[128:131], v[24:27]
    v_mfma_f32_16x16x32_bf16 v[28:31], v[172:175], v[128:131], v[28:31]
    v_mfma_f32_16x16x32_bf16 v[32:35], v[144:147], v[132:135], v[32:35]
    v_mfma_f32_16x16x32_bf16 v[36:39], v[148:151], v[132:135], v[36:39]
    v_mfma_f32_16x16x32_bf16 v[40:43], v[152:155], v[132:135], v[40:43]
    v_mfma_f32_16x16x32_bf16 v[44:47], v[156:159], v[132:135], v[44:47]
    v_mfma_f32_16x16x32_bf16 v[48:51], v[160:163], v[132:135], v[48:51]
    v_mfma_f32_16x16x32_bf16 v[52:55], v[164:167], v[132:135], v[52:55]
    v_mfma_f32_16x16x32_bf16 v[56:59], v[168:171], v[132:135], v[56:59]
    v_mfma_f32_16x16x32_bf16 v[60:63], v[172:175], v[132:135], v[60:63]
    v_mfma_f32_16x16x32_bf16 v[64:67], v[144:147], v[136:139], v[64:67]
    v_mfma_f32_16x16x32_bf16 v[68:71], v[148:151], v[136:139], v[68:71]
    v_mfma_f32_16x16x32_bf16 v[72:75], v[152:155], v[136:139], v[72:75]
    v_mfma_f32_16x16x32_bf16 v[76:79], v[156:159], v[136:139], v[76:79]
    v_mfma_f32_16x16x32_bf16 v[80:83], v[160:163], v[136:139], v[80:83]
    v_mfma_f32_16x16x32_bf16 v[84:87], v[164:167], v[136:139], v[84:87]
    v_mfma_f32_16x16x32_bf16 v[88:91], v[168:171], v[136:139], v[88:91]
    v_mfma_f32_16x16x32_bf16 v[92:95], v[172:175], v[136:139], v[92:95]
    v_mfma_f32_16x16x32_bf16 v[96:99], v[144:147], v[140:143], v[96:99]
    v_mfma_f32_16x16x32_bf16 v[100:103], v[148:151], v[140:143], v[100:103]
    v_mfma_f32_16x16x32_bf16 v[104:107], v[152:155], v[140:143], v[104:107]
    v_mfma_f32_16x16x32_bf16 v[108:111], v[156:159], v[140:143], v[108:111]
    v_mfma_f32_16x16x32_bf16 v[112:115], v[160:163], v[140:143], v[112:115]
    v_mfma_f32_16x16x32_bf16 v[116:119], v[164:167], v[140:143], v[116:119]
    v_mfma_f32_16x16x32_bf16 v[120:123], v[168:171], v[140:143], v[120:123]
    v_mfma_f32_16x16x32_bf16 v[124:127], v[172:175], v[140:143], v[124:127]
    s_add_u32 s70, s70, 2
    s_cmp_lt_u32 s70, s29
    s_cbranch_scc1 gemm1_kernel_loop4
    s_nop 7
    s_nop 7
    s_lshl_b32 s35, s28, 4
    s_mov_b32 s39, 0
    v_cvt_pk_bf16_f32 v0, v0, v1
    v_cvt_pk_bf16_f32 v1, v2, v3
    buffer_store_dwordx2 v[0:1], v200, s[12:15], s39 offen offset:0
    v_cvt_pk_bf16_f32 v4, v4, v5
    v_cvt_pk_bf16_f32 v5, v6, v7
    buffer_store_dwordx2 v[4:5], v200, s[12:15], s39 offen offset:32
    v_cvt_pk_bf16_f32 v8, v8, v9
    v_cvt_pk_bf16_f32 v9, v10, v11
    buffer_store_dwordx2 v[8:9], v200, s[12:15], s39 offen offset:64
    v_cvt_pk_bf16_f32 v12, v12, v13
    v_cvt_pk_bf16_f32 v13, v14, v15
    buffer_store_dwordx2 v[12:13], v200, s[12:15], s39 offen offset:96
    v_cvt_pk_bf16_f32 v16, v16, v17
    v_cvt_pk_bf16_f32 v17, v18, v19
    buffer_store_dwordx2 v[16:17], v200, s[12:15], s39 offen offset:128
    v_cvt_pk_bf16_f32 v20, v20, v21
    v_cvt_pk_bf16_f32 v21, v22, v23
    buffer_store_dwordx2 v[20:21], v200, s[12:15], s39 offen offset:160
    v_cvt_pk_bf16_f32 v24, v24, v25
    v_cvt_pk_bf16_f32 v25, v26, v27
    buffer_store_dwordx2 v[24:25], v200, s[12:15], s39 offen offset:192
    v_cvt_pk_bf16_f32 v28, v28, v29
    v_cvt_pk_bf16_f32 v29, v30, v31
    buffer_store_dwordx2 v[28:29], v200, s[12:15], s39 offen offset:224
    s_add_u32 s39, s39, s35
    v_cvt_pk_bf16_f32 v32, v32, v33
    v_cvt_pk_bf16_f32 v33, v34, v35
    buffer_store_dwordx2 v[32:33], v200, s[12:15], s39 offen offset:0
    v_cvt_pk_bf16_f32 v36, v36, v37
    v_cvt_pk_bf16_f32 v37, v38, v39
    buffer_store_dwordx2 v[36:37], v200, s[12:15], s39 offen offset:32
    v_cvt_pk_bf16_f32 v40, v40, v41
    v_cvt_pk_bf16_f32 v41, v42, v43
    buffer_store_dwordx2 v[40:41], v200, s[12:15], s39 offen offset:64
    v_cvt_pk_bf16_f32 v44, v44, v45
    v_cvt_pk_bf16_f32 v45, v46, v47
    buffer_store_dwordx2 v[44:45], v200, s[12:15], s39 offen offset:96
    v_cvt_pk_bf16_f32 v48, v48, v49
    v_cvt_pk_bf16_f32 v49, v50, v51
    buffer_store_dwordx2 v[48:49], v200, s[12:15], s39 offen offset:128
    v_cvt_pk_bf16_f32 v52, v52, v53
    v_cvt_pk_bf16_f32 v53, v54, v55
    buffer_store_dwordx2 v[52:53], v200, s[12:15], s39 offen offset:160
    v_cvt_pk_bf16_f32 v56, v56, v57
    v_cvt_pk_bf16_f32 v57, v58, v59
    buffer_store_dwordx2 v[56:57], v200, s[12:15], s39 offen offset:192
    v_cvt_pk_bf16_f32 v60, v60, v61
    v_cvt_pk_bf16_f32 v61, v62, v63
    buffer_store_dwordx2 v[60:61], v200, s[12:15], s39 offen offset:224
    s_add_u32 s39, s39, s35
    v_cvt_pk_bf16_f32 v64, v64, v65
    v_cvt_pk_bf16_f32 v65, v66, v67
    buffer_store_dwordx2 v[64:65], v200, s[12:15], s39 offen offset:0
    v_cvt_pk_bf16_f32 v68, v68, v69
    v_cvt_pk_bf16_f32 v69, v70, v71
    buffer_store_dwordx2 v[68:69], v200, s[12:15], s39 offen offset:32
    v_cvt_pk_bf16_f32 v72, v72, v73
    v_cvt_pk_bf16_f32 v73, v74, v75
    buffer_store_dwordx2 v[72:73], v200, s[12:15], s39 offen offset:64
    v_cvt_pk_bf16_f32 v76, v76, v77
    v_cvt_pk_bf16_f32 v77, v78, v79
    buffer_store_dwordx2 v[76:77], v200, s[12:15], s39 offen offset:96
    v_cvt_pk_bf16_f32 v80, v80, v81
    v_cvt_pk_bf16_f32 v81, v82, v83
    buffer_store_dwordx2 v[80:81], v200, s[12:15], s39 offen offset:128
    v_cvt_pk_bf16_f32 v84, v84, v85
    v_cvt_pk_bf16_f32 v85, v86, v87
    buffer_store_dwordx2 v[84:85], v200, s[12:15], s39 offen offset:160
    v_cvt_pk_bf16_f32 v88, v88, v89
    v_cvt_pk_bf16_f32 v89, v90, v91
    buffer_store_dwordx2 v[88:89], v200, s[12:15], s39 offen offset:192
    v_cvt_pk_bf16_f32 v92, v92, v93
    v_cvt_pk_bf16_f32 v93, v94, v95
    buffer_store_dwordx2 v[92:93], v200, s[12:15], s39 offen offset:224
    s_add_u32 s39, s39, s35
    v_cvt_pk_bf16_f32 v96, v96, v97
    v_cvt_pk_bf16_f32 v97, v98, v99
    buffer_store_dwordx2 v[96:97], v200, s[12:15], s39 offen offset:0
    v_cvt_pk_bf16_f32 v100, v100, v101
    v_cvt_pk_bf16_f32 v101, v102, v103
    buffer_store_dwordx2 v[100:101], v200, s[12:15], s39 offen offset:32
    v_cvt_pk_bf16_f32 v104, v104, v105
    v_cvt_pk_bf16_f32 v105, v106, v107
    buffer_store_dwordx2 v[104:105], v200, s[12:15], s39 offen offset:64
    v_cvt_pk_bf16_f32 v108, v108, v109
    v_cvt_pk_bf16_f32 v109, v110, v111
    buffer_store_dwordx2 v[108:109], v200, s[12:15], s39 offen offset:96
    v_cvt_pk_bf16_f32 v112, v112, v113
    v_cvt_pk_bf16_f32 v113, v114, v115
    buffer_store_dwordx2 v[112:113], v200, s[12:15], s39 offen offset:128
    v_cvt_pk_bf16_f32 v116, v116, v117
    v_cvt_pk_bf16_f32 v117, v118, v119
    buffer_store_dwordx2 v[116:117], v200, s[12:15], s39 offen offset:160
    v_cvt_pk_bf16_f32 v120, v120, v121
    v_cvt_pk_bf16_f32 v121, v122, v123
    buffer_store_dwordx2 v[120:121], v200, s[12:15], s39 offen offset:192
    v_cvt_pk_bf16_f32 v124, v124, v125
    v_cvt_pk_bf16_f32 v125, v126, v127
    buffer_store_dwordx2 v[124:125], v200, s[12:15], s39 offen offset:224
    s_add_u32 s39, s39, s35
gemm1_kernel_end:
    s_endpgm
.section .rodata,"a"
.p2align 6
.amdhsa_kernel gemm1_kernel
  .amdhsa_next_free_vgpr 209
  .amdhsa_next_free_sgpr 102
  .amdhsa_accum_offset 212
  .amdhsa_group_segment_fixed_size 0
  .amdhsa_kernarg_size 104
  .amdhsa_user_sgpr_count 2
  .amdhsa_user_sgpr_kernarg_segment_ptr 1
  .amdhsa_system_sgpr_workgroup_id_x 1
.end_amdhsa_kernel

.text
.globl rec_kernel
.p2align 8
.type rec_kernel,@function
rec_kernel:
    s_cmp_ge_u32 s2, 256
    s_cbranch_scc1 rec_kernel_end
    s_load_dwordx16 s[40:55], s[0:1], 0
    s_load_dwordx8 s[56:63], s[0:1], 64
    s_load_dwordx2 s[64:65], s[0:1], 96
    v_and_b32 v224, 63, v0
    v_lshrrev_b32 v227, 6, v0
    s_nop 1
    v_readfirstlane_b32 s3, v227
    v_and_b32 v225, 15, v224
    v_lshrrev_b32 v226, 4, v224
    s_lshr_b32 s20, s2, 3
    s_and_b32 s21, s2, 7
    s_waitcnt lgkmcnt(0)
    s_mov_b32 s4, s64
    s_and_b32 s5, s65, 0xffff
    s_mov_b32 s6, 0x10000000
    s_mov_b32 s7, 0x00020000
    s_lshl_b32 s24, s20, 7
    s_lshl_b32 s25, s21, 4
    s_add_u32 s24, s24, s25
    v_add_u32 v227, s24, v225
    v_lshlrev_b32 v227, 1, v227
    v_lshl_add_u32 v227, v226, 16, v227
    s_lshl_b32 s26, s3, 21
    s_mov_b32 s8, s50
    s_and_b32 s9, s51, 0xffff
    s_mov_b32 s10, 0x800000
    s_mov_b32 s11, 0x00020000
    s_mov_b32 s27, s26
    buffer_load_ushort v132, v227, s[8:11], s27 offen
    s_add_u32 s27, s27, 8192
    buffer_load_ushort v133, v227, s[8:11], s27 offen
    s_add_u32 s27, s27, 8192
    buffer_load_ushort v134, v227, s[8:11], s27 offen
    s_add_u32 s27, s27, 8192
    buffer_load_ushort v135, v227, s[8:11], s27 offen
    s_add_u32 s27, s27, 8192
    buffer_load_ushort v136, v227, s[8:11], s27 offen
    s_add_u32 s27, s27, 8192
    buffer_load_ushort v137, v227, s[8:11], s27 offen
    s_add_u32 s27, s27, 8192
    buffer_load_ushort v138, v227, s[8:11], s27 offen
    s_add_u32 s27, s27, 8192
    buffer_load_ushort v139, v227, s[8:11], s27 offen
    s_add_u32 s27, s27, 8192
    s_add_u32 s27, s27, 196608
    buffer_load_ushort v140, v227, s[8:11], s27 offen
    s_add_u32 s27, s27, 8192
    buffer_load_ushort v141, v227, s[8:11], s27 offen
    s_add_u32 s27, s27, 8192
    buffer_load_ushort v142, v227, s[8:11], s27 offen
    s_add_u32 s27, s27, 8192
    buffer_load_ushort v143, v227, s[8:11], s27 offen
    s_add_u32 s27, s27, 8192
    buffer_load_ushort v144, v227, s[8:11], s27 offen
    s_add_u32 s27, s27, 8192
    buffer_load_ushort v145, v227, s[8:11], s27 offen
    s_add_u32 s27, s27, 8192
    buffer_load_ushort v146, v227, s[8:11], s27 offen
    s_add_u32 s27, s27, 8192
    buffer_load_ushort v147, v227, s[8:11], s27 offen
    s_add_u32 s27, s27, 8192
    s_add_u32 s27, s27, 196608
    buffer_load_ushort v148, v227, s[8:11], s27 offen
    s_add_u32 s27, s27, 8192
    buffer_load_ushort v149, v227, s[8:11], s27 offen
    s_add_u32 s27, s27, 8192
    buffer_load_ushort v150, v227, s[8:11], s27 offen
    s_add_u32 s27, s27, 8192
    buffer_load_ushort v151, v227, s[8:11], s27 offen
    s_add_u32 s27, s27, 8192
    buffer_load_ushort v152, v227, s[8:11], s27 offen
    s_add_u32 s27, s27, 8192
    buffer_load_ushort v153, v227, s[8:11], s27 offen
    s_add_u32 s27, s27, 8192
    buffer_load_ushort v154, v227, s[8:11], s27 offen
    s_add_u32 s27, s27, 8192
    buffer_load_ushort v155, v227, s[8:11], s27 offen
    s_add_u32 s27, s27, 8192
    s_add_u32 s27, s27, 196608
    buffer_load_ushort v156, v227, s[8:11], s27 offen
    s_add_u32 s27, s27, 8192
    buffer_load_ushort v157, v227, s[8:11], s27 offen
    s_add_u32 s27, s27, 8192
    buffer_load_ushort v158, v227, s[8:11], s27 offen
    s_add_u32 s27, s27, 8192
    buffer_load_ushort v159, v227, s[8:11], s27 offen
    s_add_u32 s27, s27, 8192
    buffer_load_ushort v160, v227, s[8:11], s27 offen
    s_add_u32 s27, s27, 8192
    buffer_load_ushort v161, v227, s[8:11], s27 offen
    s_add_u32 s27, s27, 8192
    buffer_load_ushort v162, v227, s[8:11], s27 offen
    s_add_u32 s27, s27, 8192
    buffer_load_ushort v163, v227, s[8:11], s27 offen
    s_add_u32 s27, s27, 8192
    s_add_u32 s27, s27, 196608
    s_waitcnt vmcnt(0)
    v_lshl_or_b32 v4, v133, 16, v132
    v_lshl_or_b32 v5, v135, 16, v134
    v_lshl_or_b32 v6, v137, 16, v136
    v_lshl_or_b32 v7, v139, 16, v138
    v_lshl_or_b32 v16, v141, 16, v140
    v_lshl_or_b32 v17, v143, 16, v142
    v_lshl_or_b32 v18, v145, 16, v144
    v_lshl_or_b32 v19, v147, 16, v146
    v_lshl_or_b32 v28, v149, 16, v148
    v_lshl_or_b32 v29, v151, 16, v150
    v_lshl_or_b32 v30, v153, 16, v152
    v_lshl_or_b32 v31, v155, 16, v154
    v_lshl_or_b32 v40, v157, 16, v156
    v_lshl_or_b32 v41, v159, 16, v158
    v_lshl_or_b32 v42, v161, 16, v160
    v_lshl_or_b32 v43, v163, 16, v162
    buffer_load_ushort v132, v227, s[8:11], s27 offen
    s_add_u32 s27, s27, 8192
    buffer_load_ushort v133, v227, s[8:11], s27 offen
    s_add_u32 s27, s27, 8192
    buffer_load_ushort v134, v227, s[8:11], s27 offen
    s_add_u32 s27, s27, 8192
    buffer_load_ushort v135, v227, s[8:11], s27 offen
    s_add_u32 s27, s27, 8192
    buffer_load_ushort v136, v227, s[8:11], s27 offen
    s_add_u32 s27, s27, 8192
    buffer_load_ushort v137, v227, s[8:11], s27 offen
    s_add_u32 s27, s27, 8192
    buffer_load_ushort v138, v227, s[8:11], s27 offen
    s_add_u32 s27, s27, 8192
    buffer_load_ushort v139, v227, s[8:11], s27 offen
    s_add_u32 s27, s27, 8192
    s_add_u32 s27, s27, 196608
    buffer_load_ushort v140, v227, s[8:11], s27 offen
    s_add_u32 s27, s27, 8192
    buffer_load_ushort v141, v227, s[8:11], s27 offen
    s_add_u32 s27, s27, 8192
    buffer_load_ushort v142, v227, s[8:11], s27 offen
    s_add_u32 s27, s27, 8192
    buffer_load_ushort v143, v227, s[8:11], s27 offen
    s_add_u32 s27, s27, 8192
    buffer_load_ushort v144, v227, s[8:11], s27 offen
    s_add_u32 s27, s27, 8192
    buffer_load_ushort v145, v227, s[8:11], s27 offen
    s_add_u32 s27, s27, 8192
    buffer_load_ushort v146, v227, s[8:11], s27 offen
    s_add_u32 s27, s27, 8192
    buffer_load_ushort v147, v227, s[8:11], s27 offen
    s_add_u32 s27, s27, 8192
    s_add_u32 s27, s27, 196608
    buffer_load_ushort v148, v227, s[8:11], s27 offen
    s_add_u32 s27, s27, 8192
    buffer_load_ushort v149, v227, s[8:11], s27 offen
    s_add_u32 s27, s27, 8192
    buffer_load_ushort v150, v227, s[8:11], s27 offen
    s_add_u32 s27, s27, 8192
    buffer_load_ushort v151, v227, s[8:11], s27 offen
    s_add_u32 s27, s27, 8192
    buffer_load_ushort v152, v227, s[8:11], s27 offen
    s_add_u32 s27, s27, 8192
    buffer_load_ushort v153, v227, s[8:11], s27 offen
    s_add_u32 s27, s27, 8192
    buffer_load_ushort v154, v227, s[8:11], s27 offen
    s_add_u32 s27, s27, 8192
    buffer_load_ushort v155, v227, s[8:11], s27 offen
    s_add_u32 s27, s27, 8192
    s_add_u32 s27, s27, 196608
    buffer_load_ushort v156, v227, s[8:11], s27 offen
    s_add_u32 s27, s27, 8192
    buffer_load_ushort v157, v227, s[8:11], s27 offen
    s_add_u32 s27, s27, 8192
    buffer_load_ushort v158, v227, s[8:11], s27 offen
    s_add_u32 s27, s27, 8192
    buffer_load_ushort v159, v227, s[8:11], s27 offen
    s_add_u32 s27, s27, 8192
    buffer_load_ushort v160, v227, s[8:11], s27 offen
    s_add_u32 s27, s27, 8192
    buffer_load_ushort v161, v227, s[8:11], s27 offen
    s_add_u32 s27, s27, 8192
    buffer_load_ushort v162, v227, s[8:11], s27 offen
    s_add_u32 s27, s27, 8192
    buffer_load_ushort v163, v227, s[8:11], s27 offen
    s_add_u32 s27, s27, 8192
    s_add_u32 s27, s27, 196608
    s_waitcnt vmcnt(0)
    v_lshl_or_b32 v52, v133, 16, v132
    v_lshl_or_b32 v53, v135, 16, v134
    v_lshl_or_b32 v54, v137, 16, v136
    v_lshl_or_b32 v55, v139, 16, v138
    v_lshl_or_b32 v64, v141, 16, v140
    v_lshl_or_b32 v65, v143, 16, v142
    v_lshl_or_b32 v66, v145, 16, v144
    v_lshl_or_b32 v67, v147, 16, v146
    v_lshl_or_b32 v76, v149, 16, v148
    v_lshl_or_b32 v77, v151, 16, v150
    v_lshl_or_b32 v78, v153, 16, v152
    v_lshl_or_b32 v79, v155, 16, v154
    v_lshl_or_b32 v88, v157, 16, v156
    v_lshl_or_b32 v89, v159, 16, v158
    v_lshl_or_b32 v90, v161, 16, v160
    v_lshl_or_b32 v91, v163, 16, v162
    s_mov_b32 s8, s52
    s_and_b32 s9, s53, 0xffff
    s_mov_b32 s10, 0x800000
    s_mov_b32 s11, 0x00020000
    s_mov_b32 s27, s26
    buffer_load_ushort v132, v227, s[8:11], s27 offen
    s_add_u32 s27, s27, 8192
    buffer_load_ushort v133, v227, s[8:11], s27 offen
    s_add_u32 s27, s27, 8192
    buffer_load_ushort v134, v227, s[8:11], s27 offen
    s_add_u32 s27, s27, 8192
    buffer_load_ushort v135, v227, s[8:11], s27 offen
    s_add_u32 s27, s27, 8192
    buffer_load_ushort v136, v227, s[8:11], s27 offen
    s_add_u32 s27, s27, 8192
    buffer_load_ushort v137, v227, s[8:11], s27 offen
    s_add_u32 s27, s27, 8192
    buffer_load_ushort v138, v227, s[8:11], s27 offen
    s_add_u32 s27, s27, 8192
    buffer_load_ushort v139, v227, s[8:11], s27 offen
    s_add_u32 s27, s27, 8192
    s_add_u32 s27, s27, 196608
    buffer_load_ushort v140, v227, s[8:11], s27 offen
    s_add_u32 s27, s27, 8192
    buffer_load_ushort v141, v227, s[8:11], s27 offen
    s_add_u32 s27, s27, 8192
    buffer_load_ushort v142, v227, s[8:11], s27 offen
    s_add_u32 s27, s27, 8192
    buffer_load_ushort v143, v227, s[8:11], s27 offen
    s_add_u32 s27, s27, 8192
    buffer_load_ushort v144, v227, s[8:11], s27 offen
    s_add_u32 s27, s27, 8192
    buffer_load_ushort v145, v227, s[8:11], s27 offen
    s_add_u32 s27, s27, 8192
    buffer_load_ushort v146, v227, s[8:11], s27 offen
    s_add_u32 s27, s27, 8192
    buffer_load_ushort v147, v227, s[8:11], s27 offen
    s_add_u32 s27, s27, 8192
    s_add_u32 s27, s27, 196608
    buffer_load_ushort v148, v227, s[8:11], s27 offen
    s_add_u32 s27, s27, 8192
    buffer_load_ushort v149, v227, s[8:11], s27 offen
    s_add_u32 s27, s27, 8192
    buffer_load_ushort v150, v227, s[8:11], s27 offen
    s_add_u32 s27, s27, 8192
    buffer_load_ushort v151, v227, s[8:11], s27 offen
    s_add_u32 s27, s27, 8192
    buffer_load_ushort v152, v227, s[8:11], s27 offen
    s_add_u32 s27, s27, 8192
    buffer_load_ushort v153, v227, s[8:11], s27 offen
    s_add_u32 s27, s27, 8192
    buffer_load_ushort v154, v227, s[8:11], s27 offen
    s_add_u32 s27, s27, 8192
    buffer_load_ushort v155, v227, s[8:11], s27 offen
    s_add_u32 s27, s27, 8192
    s_add_u32 s27, s27, 196608
    buffer_load_ushort v156, v227, s[8:11], s27 offen
    s_add_u32 s27, s27, 8192
    buffer_load_ushort v157, v227, s[8:11], s27 offen
    s_add_u32 s27, s27, 8192
    buffer_load_ushort v158, v227, s[8:11], s27 offen
    s_add_u32 s27, s27, 8192
    buffer_load_ushort v159, v227, s[8:11], s27 offen
    s_add_u32 s27, s27, 8192
    buffer_load_ushort v160, v227, s[8:11], s27 offen
    s_add_u32 s27, s27, 8192
    buffer_load_ushort v161, v227, s[8:11], s27 offen
    s_add_u32 s27, s27, 8192
    buffer_load_ushort v162, v227, s[8:11], s27 offen
    s_add_u32 s27, s27, 8192
    buffer_load_ushort v163, v227, s[8:11], s27 offen
    s_add_u32 s27, s27, 8192
    s_add_u32 s27, s27, 196608
    s_waitcnt vmcnt(0)
    v_lshl_or_b32 v8, v133, 16, v132
    v_lshl_or_b32 v9, v135, 16, v134
    v_lshl_or_b32 v10, v137, 16, v136
    v_lshl_or_b32 v11, v139, 16, v138
    v_lshl_or_b32 v20, v141, 16, v140
    v_lshl_or_b32 v21, v143, 16, v142
    v_lshl_or_b32 v22, v145, 16, v144
    v_lshl_or_b32 v23, v147, 16, v146
    v_lshl_or_b32 v32, v149, 16, v148
    v_lshl_or_b32 v33, v151, 16, v150
    v_lshl_or_b32 v34, v153, 16, v152
    v_lshl_or_b32 v35, v155, 16, v154
    v_lshl_or_b32 v44, v157, 16, v156
    v_lshl_or_b32 v45, v159, 16, v158
    v_lshl_or_b32 v46, v161, 16, v160
    v_lshl_or_b32 v47, v163, 16, v162
    buffer_load_ushort v132, v227, s[8:11], s27 offen
    s_add_u32 s27, s27, 8192
    buffer_load_ushort v133, v227, s[8:11], s27 offen
    s_add_u32 s27, s27, 8192
    buffer_load_ushort v134, v227, s[8:11], s27 offen
    s_add_u32 s27, s27, 8192
    buffer_load_ushort v135, v227, s[8:11], s27 offen
    s_add_u32 s27, s27, 8192
    buffer_load_ushort v136, v227, s[8:11], s27 offen
    s_add_u32 s27, s27, 8192
    buffer_load_ushort v137, v227, s[8:11], s27 offen
    s_add_u32 s27, s27, 8192
    buffer_load_ushort v138, v227, s[8:11], s27 offen
    s_add_u32 s27, s27, 8192
    buffer_load_ushort v139, v227, s[8:11], s27 offen
    s_add_u32 s27, s27, 8192
    s_add_u32 s27, s27, 196608
    buffer_load_ushort v140, v227, s[8:11], s27 offen
    s_add_u32 s27, s27, 8192
    buffer_load_ushort v141, v227, s[8:11], s27 offen
    s_add_u32 s27, s27, 8192
    buffer_load_ushort v142, v227, s[8:11], s27 offen
    s_add_u32 s27, s27, 8192
    buffer_load_ushort v143, v227, s[8:11], s27 offen
    s_add_u32 s27, s27, 8192
    buffer_load_ushort v144, v227, s[8:11], s27 offen
    s_add_u32 s27, s27, 8192
    buffer_load_ushort v145, v227, s[8:11], s27 offen
    s_add_u32 s27, s27, 8192
    buffer_load_ushort v146, v227, s[8:11], s27 offen
    s_add_u32 s27, s27, 8192
    buffer_load_ushort v147, v227, s[8:11], s27 offen
    s_add_u32 s27, s27, 8192
    s_add_u32 s27, s27, 196608
    buffer_load_ushort v148, v227, s[8:11], s27 offen
    s_add_u32 s27, s27, 8192
    buffer_load_ushort v149, v227, s[8:11], s27 offen
    s_add_u32 s27, s27, 8192
    buffer_load_ushort v150, v227, s[8:11], s27 offen
    s_add_u32 s27, s27, 8192
    buffer_load_ushort v151, v227, s[8:11], s27 offen
    s_add_u32 s27, s27, 8192
    buffer_load_ushort v152, v227, s[8:11], s27 offen
    s_add_u32 s27, s27, 8192
    buffer_load_ushort v153, v227, s[8:11], s27 offen
    s_add_u32 s27, s27, 8192
    buffer_load_ushort v154, v227, s[8:11], s27 offen
    s_add_u32 s27, s27, 8192
    buffer_load_ushort v155, v227, s[8:11], s27 offen
    s_add_u32 s27, s27, 8192
    s_add_u32 s27, s27, 196608
    buffer_load_ushort v156, v227, s[8:11], s27 offen
    s_add_u32 s27, s27, 8192
    buffer_load_ushort v157, v227, s[8:11], s27 offen
    s_add_u32 s27, s27, 8192
    buffer_load_ushort v158, v227, s[8:11], s27 offen
    s_add_u32 s27, s27, 8192
    buffer_load_ushort v159, v227, s[8:11], s27 offen
    s_add_u32 s27, s27, 8192
    buffer_load_ushort v160, v227, s[8:11], s27 offen
    s_add_u32 s27, s27, 8192
    buffer_load_ushort v161, v227, s[8:11], s27 offen
    s_add_u32 s27, s27, 8192
    buffer_load_ushort v162, v227, s[8:11], s27 offen
    s_add_u32 s27, s27, 8192
    buffer_load_ushort v163, v227, s[8:11], s27 offen
    s_add_u32 s27, s27, 8192
    s_add_u32 s27, s27, 196608
    s_waitcnt vmcnt(0)
    v_lshl_or_b32 v56, v133, 16, v132
    v_lshl_or_b32 v57, v135, 16, v134
    v_lshl_or_b32 v58, v137, 16, v136
    v_lshl_or_b32 v59, v139, 16, v138
    v_lshl_or_b32 v68, v141, 16, v140
    v_lshl_or_b32 v69, v143, 16, v142
    v_lshl_or_b32 v70, v145, 16, v144
    v_lshl_or_b32 v71, v147, 16, v146
    v_lshl_or_b32 v80, v149, 16, v148
    v_lshl_or_b32 v81, v151, 16, v150
    v_lshl_or_b32 v82, v153, 16, v152
    v_lshl_or_b32 v83, v155, 16, v154
    v_lshl_or_b32 v92, v157, 16, v156
    v_lshl_or_b32 v93, v159, 16, v158
    v_lshl_or_b32 v94, v161, 16, v160
    v_lshl_or_b32 v95, v163, 16, v162
    s_mov_b32 s8, s54
    s_and_b32 s9, s55, 0xffff
    s_mov_b32 s10, 0x800000
    s_mov_b32 s11, 0x00020000
    s_mov_b32 s27, s26
    buffer_load_ushort v132, v227, s[8:11], s27 offen
    s_add_u32 s27, s27, 8192
    buffer_load_ushort v133, v227, s[8:11], s27 offen
    s_add_u32 s27, s27, 8192
    buffer_load_ushort v134, v227, s[8:11], s27 offen
    s_add_u32 s27, s27, 8192
    buffer_load_ushort v135, v227, s[8:11], s27 offen
    s_add_u32 s27, s27, 8192
    buffer_load_ushort v136, v227, s[8:11], s27 offen
    s_add_u32 s27, s27, 8192
    buffer_load_ushort v137, v227, s[8:11], s27 offen
    s_add_u32 s27, s27, 8192
    buffer_load_ushort v138, v227, s[8:11], s27 offen
    s_add_u32 s27, s27, 8192
    buffer_load_ushort v139, v227, s[8:11], s27 offen
    s_add_u32 s27, s27, 8192
    s_add_u32 s27, s27, 196608
    buffer_load_ushort v140, v227, s[8:11], s27 offen
    s_add_u32 s27, s27, 8192
    buffer_load_ushort v141, v227, s[8:11], s27 offen
    s_add_u32 s27, s27, 8192
    buffer_load_ushort v142, v227, s[8:11], s27 offen
    s_add_u32 s27, s27, 8192
    buffer_load_ushort v143, v227, s[8:11], s27 offen
    s_add_u32 s27, s27, 8192
    buffer_load_ushort v144, v227, s[8:11], s27 offen
    s_add_u32 s27, s27, 8192
    buffer_load_ushort v145, v227, s[8:11], s27 offen
    s_add_u32 s27, s27, 8192
    buffer_load_ushort v146, v227, s[8:11], s27 offen
    s_add_u32 s27, s27, 8192
    buffer_load_ushort v147, v227, s[8:11], s27 offen
    s_add_u32 s27, s27, 8192
    s_add_u32 s27, s27, 196608
    buffer_load_ushort v148, v227, s[8:11], s27 offen
    s_add_u32 s27, s27, 8192
    buffer_load_ushort v149, v227, s[8:11], s27 offen
    s_add_u32 s27, s27, 8192
    buffer_load_ushort v150, v227, s[8:11], s27 offen
    s_add_u32 s27, s27, 8192
    buffer_load_ushort v151, v227, s[8:11], s27 offen
    s_add_u32 s27, s27, 8192
    buffer_load_ushort v152, v227, s[8:11], s27 offen
    s_add_u32 s27, s27, 8192
    buffer_load_ushort v153, v227, s[8:11], s27 offen
    s_add_u32 s27, s27, 8192
    buffer_load_ushort v154, v227, s[8:11], s27 offen
    s_add_u32 s27, s27, 8192
    buffer_load_ushort v155, v227, s[8:11], s27 offen
    s_add_u32 s27, s27, 8192
    s_add_u32 s27, s27, 196608
    buffer_load_ushort v156, v227, s[8:11], s27 offen
    s_add_u32 s27, s27, 8192
    buffer_load_ushort v157, v227, s[8:11], s27 offen
    s_add_u32 s27, s27, 8192
    buffer_load_ushort v158, v227, s[8:11], s27 offen
    s_add_u32 s27, s27, 8192
    buffer_load_ushort v159, v227, s[8:11], s27 offen
    s_add_u32 s27, s27, 8192
    buffer_load_ushort v160, v227, s[8:11], s27 offen
    s_add_u32 s27, s27, 8192
    buffer_load_ushort v161, v227, s[8:11], s27 offen
    s_add_u32 s27, s27, 8192
    buffer_load_ushort v162, v227, s[8:11], s27 offen
    s_add_u32 s27, s27, 8192
    buffer_load_ushort v163, v227, s[8:11], s27 offen
    s_add_u32 s27, s27, 8192
    s_add_u32 s27, s27, 196608
    s_waitcnt vmcnt(0)
    v_lshl_or_b32 v12, v133, 16, v132
    v_lshl_or_b32 v13, v135, 16, v134
    v_lshl_or_b32 v14, v137, 16, v136
    v_lshl_or_b32 v15, v139, 16, v138
    v_lshl_or_b32 v24, v141, 16, v140
    v_lshl_or_b32 v25, v143, 16, v142
    v_lshl_or_b32 v26, v145, 16, v144
    v_lshl_or_b32 v27, v147, 16, v146
    v_lshl_or_b32 v36, v149, 16, v148
    v_lshl_or_b32 v37, v151, 16, v150
    v_lshl_or_b32 v38, v153, 16, v152
    v_lshl_or_b32 v39, v155, 16, v154
    v_lshl_or_b32 v48, v157, 16, v156
    v_lshl_or_b32 v49, v159, 16, v158
    v_lshl_or_b32 v50, v161, 16, v160
    v_lshl_or_b32 v51, v163, 16, v162
    buffer_load_ushort v132, v227, s[8:11], s27 offen
    s_add_u32 s27, s27, 8192
    buffer_load_ushort v133, v227, s[8:11], s27 offen
    s_add_u32 s27, s27, 8192
    buffer_load_ushort v134, v227, s[8:11], s27 offen
    s_add_u32 s27, s27, 8192
    buffer_load_ushort v135, v227, s[8:11], s27 offen
    s_add_u32 s27, s27, 8192
    buffer_load_ushort v136, v227, s[8:11], s27 offen
    s_add_u32 s27, s27, 8192
    buffer_load_ushort v137, v227, s[8:11], s27 offen
    s_add_u32 s27, s27, 8192
    buffer_load_ushort v138, v227, s[8:11], s27 offen
    s_add_u32 s27, s27, 8192
    buffer_load_ushort v139, v227, s[8:11], s27 offen
    s_add_u32 s27, s27, 8192
    s_add_u32 s27, s27, 196608
    buffer_load_ushort v140, v227, s[8:11], s27 offen
    s_add_u32 s27, s27, 8192
    buffer_load_ushort v141, v227, s[8:11], s27 offen
    s_add_u32 s27, s27, 8192
    buffer_load_ushort v142, v227, s[8:11], s27 offen
    s_add_u32 s27, s27, 8192
    buffer_load_ushort v143, v227, s[8:11], s27 offen
    s_add_u32 s27, s27, 8192
    buffer_load_ushort v144, v227, s[8:11], s27 offen
    s_add_u32 s27, s27, 8192
    buffer_load_ushort v145, v227, s[8:11], s27 offen
    s_add_u32 s27, s27, 8192
    buffer_load_ushort v146, v227, s[8:11], s27 offen
    s_add_u32 s27, s27, 8192
    buffer_load_ushort v147, v227, s[8:11], s27 offen
    s_add_u32 s27, s27, 8192
    s_add_u32 s27, s27, 196608
    buffer_load_ushort v148, v227, s[8:11], s27 offen
    s_add_u32 s27, s27, 8192
    buffer_load_ushort v149, v227, s[8:11], s27 offen
    s_add_u32 s27, s27, 8192
    buffer_load_ushort v150, v227, s[8:11], s27 offen
    s_add_u32 s27, s27, 8192
    buffer_load_ushort v151, v227, s[8:11], s27 offen
    s_add_u32 s27, s27, 8192
    buffer_load_ushort v152, v227, s[8:11], s27 offen
    s_add_u32 s27, s27, 8192
    buffer_load_ushort v153, v227, s[8:11], s27 offen
    s_add_u32 s27, s27, 8192
    buffer_load_ushort v154, v227, s[8:11], s27 offen
    s_add_u32 s27, s27, 8192
    buffer_load_ushort v155, v227, s[8:11], s27 offen
    s_add_u32 s27, s27, 8192
    s_add_u32 s27, s27, 196608
    buffer_load_ushort v156, v227, s[8:11], s27 offen
    s_add_u32 s27, s27, 8192
    buffer_load_ushort v157, v227, s[8:11], s27 offen
    s_add_u32 s27, s27, 8192
    buffer_load_ushort v158, v227, s[8:11], s27 offen
    s_add_u32 s27, s27, 8192
    buffer_load_ushort v159, v227, s[8:11], s27 offen
    s_add_u32 s27, s27, 8192
    buffer_load_ushort v160, v227, s[8:11], s27 offen
    s_add_u32 s27, s27, 8192
    buffer_load_ushort v161, v227, s[8:11], s27 offen
    s_add_u32 s27, s27, 8192
    buffer_load_ushort v162, v227, s[8:11], s27 offen
    s_add_u32 s27, s27, 8192
    buffer_load_ushort v163, v227, s[8:11], s27 offen
    s_add_u32 s27, s27, 8192
    s_add_u32 s27, s27, 196608
    s_waitcnt vmcnt(0)
    v_lshl_or_b32 v60, v133, 16, v132
    v_lshl_or_b32 v61, v135, 16, v134
    v_lshl_or_b32 v62, v137, 16, v136
    v_lshl_or_b32 v63, v139, 16, v138
    v_lshl_or_b32 v72, v141, 16, v140
    v_lshl_or_b32 v73, v143, 16, v142
    v_lshl_or_b32 v74, v145, 16, v144
    v_lshl_or_b32 v75, v147, 16, v146
    v_lshl_or_b32 v84, v149, 16, v148
    v_lshl_or_b32 v85, v151, 16, v150
    v_lshl_or_b32 v86, v153, 16, v152
    v_lshl_or_b32 v87, v155, 16, v154
    v_lshl_or_b32 v96, v157, 16, v156
    v_lshl_or_b32 v97, v159, 16, v158
    v_lshl_or_b32 v98, v161, 16, v160
    v_lshl_or_b32 v99, v163, 16, v162
    s_mov_b32 s8, s56
    s_and_b32 s9, s57, 0xffff
    s_mov_b32 s10, 0x800000
    s_mov_b32 s11, 0x00020000
    s_lshl_b32 s24, s21, 7
    s_lshl_b32 s25, s3, 5
    s_add_u32 s24, s24, s25
    v_add_u32 v227, s24, v225
    v_lshlrev_b32 v227, 1, v227
    v_lshl_add_u32 v227, v226, 14, v227
    s_lshl_b32 s26, s20, 18
    s_mov_b32 s27, s26
    buffer_load_ushort v132, v227, s[8:11], s27 offen offset:0
    s_add_u32 s27, s27, 2048
    buffer_load_ushort v133, v227, s[8:11], s27 offen offset:0
    s_add_u32 s27, s27, 2048
    buffer_load_ushort v134, v227, s[8:11], s27 offen offset:0
    s_add_u32 s27, s27, 2048
    buffer_load_ushort v135, v227, s[8:11], s27 offen offset:0
    s_add_u32 s27, s27, 2048
    buffer_load_ushort v136, v227, s[8:11], s27 offen offset:0
    s_add_u32 s27, s27, 2048
    buffer_load_ushort v137, v227, s[8:11], s27 offen offset:0
    s_add_u32 s27, s27, 2048
    buffer_load_ushort v138, v227, s[8:11], s27 offen offset:0
    s_add_u32 s27, s27, 2048
    buffer_load_ushort v139, v227, s[8:11], s27 offen offset:0
    s_add_u32 s27, s27, 2048
    s_add_u32 s27, s27, 49152
    buffer_load_ushort v140, v227, s[8:11], s27 offen offset:0
    s_add_u32 s27, s27, 2048
    buffer_load_ushort v141, v227, s[8:11], s27 offen offset:0
    s_add_u32 s27, s27, 2048
    buffer_load_ushort v142, v227, s[8:11], s27 offen offset:0
    s_add_u32 s27, s27, 2048
    buffer_load_ushort v143, v227, s[8:11], s27 offen offset:0
    s_add_u32 s27, s27, 2048
    buffer_load_ushort v144, v227, s[8:11], s27 offen offset:0
    s_add_u32 s27, s27, 2048
    buffer_load_ushort v145, v227, s[8:11], s27 offen offset:0
    s_add_u32 s27, s27, 2048
    buffer_load_ushort v146, v227, s[8:11], s27 offen offset:0
    s_add_u32 s27, s27, 2048
    buffer_load_ushort v147, v227, s[8:11], s27 offen offset:0
    s_add_u32 s27, s27, 2048
    s_add_u32 s27, s27, 49152
    buffer_load_ushort v148, v227, s[8:11], s27 offen offset:0
    s_add_u32 s27, s27, 2048
    buffer_load_ushort v149, v227, s[8:11], s27 offen offset:0
    s_add_u32 s27, s27, 2048
    buffer_load_ushort v150, v227, s[8:11], s27 offen offset:0
    s_add_u32 s27, s27, 2048
    buffer_load_ushort v151, v227, s[8:11], s27 offen offset:0
    s_add_u32 s27, s27, 2048
    buffer_load_ushort v152, v227, s[8:11], s27 offen offset:0
    s_add_u32 s27, s27, 2048
    buffer_load_ushort v153, v227, s[8:11], s27 offen offset:0
    s_add_u32 s27, s27, 2048
    buffer_load_ushort v154, v227, s[8:11], s27 offen offset:0
    s_add_u32 s27, s27, 2048
    buffer_load_ushort v155, v227, s[8:11], s27 offen offset:0
    s_add_u32 s27, s27, 2048
    s_add_u32 s27, s27, 49152
    buffer_load_ushort v156, v227, s[8:11], s27 offen offset:0
    s_add_u32 s27, s27, 2048
    buffer_load_ushort v157, v227, s[8:11], s27 offen offset:0
    s_add_u32 s27, s27, 2048
    buffer_load_ushort v158, v227, s[8:11], s27 offen offset:0
    s_add_u32 s27, s27, 2048
    buffer_load_ushort v159, v227, s[8:11], s27 offen offset:0
    s_add_u32 s27, s27, 2048
    buffer_load_ushort v160, v227, s[8:11], s27 offen offset:0
    s_add_u32 s27, s27, 2048
    buffer_load_ushort v161, v227, s[8:11], s27 offen offset:0
    s_add_u32 s27, s27, 2048
    buffer_load_ushort v162, v227, s[8:11], s27 offen offset:0
    s_add_u32 s27, s27, 2048
    buffer_load_ushort v163, v227, s[8:11], s27 offen offset:0
    s_add_u32 s27, s27, 2048
    s_add_u32 s27, s27, 49152
    s_waitcnt vmcnt(0)
    v_lshl_or_b32 v100, v133, 16, v132
    v_lshl_or_b32 v101, v135, 16, v134
    v_lshl_or_b32 v102, v137, 16, v136
    v_lshl_or_b32 v103, v139, 16, v138
    v_lshl_or_b32 v104, v141, 16, v140
    v_lshl_or_b32 v105, v143, 16, v142
    v_lshl_or_b32 v106, v145, 16, v144
    v_lshl_or_b32 v107, v147, 16, v146
    v_lshl_or_b32 v108, v149, 16, v148
    v_lshl_or_b32 v109, v151, 16, v150
    v_lshl_or_b32 v110, v153, 16, v152
    v_lshl_or_b32 v111, v155, 16, v154
    v_lshl_or_b32 v112, v157, 16, v156
    v_lshl_or_b32 v113, v159, 16, v158
    v_lshl_or_b32 v114, v161, 16, v160
    v_lshl_or_b32 v115, v163, 16, v162
    s_mov_b32 s27, s26
    buffer_load_ushort v132, v227, s[8:11], s27 offen offset:32
    s_add_u32 s27, s27, 2048
    buffer_load_ushort v133, v227, s[8:11], s27 offen offset:32
    s_add_u32 s27, s27, 2048
    buffer_load_ushort v134, v227, s[8:11], s27 offen offset:32
    s_add_u32 s27, s27, 2048
    buffer_load_ushort v135, v227, s[8:11], s27 offen offset:32
    s_add_u32 s27, s27, 2048
    buffer_load_ushort v136, v227, s[8:11], s27 offen offset:32
    s_add_u32 s27, s27, 2048
    buffer_load_ushort v137, v227, s[8:11], s27 offen offset:32
    s_add_u32 s27, s27, 2048
    buffer_load_ushort v138, v227, s[8:11], s27 offen offset:32
    s_add_u32 s27, s27, 2048
    buffer_load_ushort v139, v227, s[8:11], s27 offen offset:32
    s_add_u32 s27, s27, 2048
    s_add_u32 s27, s27, 49152
    buffer_load_ushort v140, v227, s[8:11], s27 offen offset:32
    s_add_u32 s27, s27, 2048
    buffer_load_ushort v141, v227, s[8:11], s27 offen offset:32
    s_add_u32 s27, s27, 2048
    buffer_load_ushort v142, v227, s[8:11], s27 offen offset:32
    s_add_u32 s27, s27, 2048
    buffer_load_ushort v143, v227, s[8:11], s27 offen offset:32
    s_add_u32 s27, s27, 2048
    buffer_load_ushort v144, v227, s[8:11], s27 offen offset:32
    s_add_u32 s27, s27, 2048
    buffer_load_ushort v145, v227, s[8:11], s27 offen offset:32
    s_add_u32 s27, s27, 2048
    buffer_load_ushort v146, v227, s[8:11], s27 offen offset:32
    s_add_u32 s27, s27, 2048
    buffer_load_ushort v147, v227, s[8:11], s27 offen offset:32
    s_add_u32 s27, s27, 2048
    s_add_u32 s27, s27, 49152
    buffer_load_ushort v148, v227, s[8:11], s27 offen offset:32
    s_add_u32 s27, s27, 2048
    buffer_load_ushort v149, v227, s[8:11], s27 offen offset:32
    s_add_u32 s27, s27, 2048
    buffer_load_ushort v150, v227, s[8:11], s27 offen offset:32
    s_add_u32 s27, s27, 2048
    buffer_load_ushort v151, v227, s[8:11], s27 offen offset:32
    s_add_u32 s27, s27, 2048
    buffer_load_ushort v152, v227, s[8:11], s27 offen offset:32
    s_add_u32 s27, s27, 2048
    buffer_load_ushort v153, v227, s[8:11], s27 offen offset:32
    s_add_u32 s27, s27, 2048
    buffer_load_ushort v154, v227, s[8:11], s27 offen offset:32
    s_add_u32 s27, s27, 2048
    buffer_load_ushort v155, v227, s[8:11], s27 offen offset:32
    s_add_u32 s27, s27, 2048
    s_add_u32 s27, s27, 49152
    buffer_load_ushort v156, v227, s[8:11], s27 offen offset:32
    s_add_u32 s27, s27, 2048
    buffer_load_ushort v157, v227, s[8:11], s27 offen offset:32
    s_add_u32 s27, s27, 2048
    buffer_load_ushort v158, v227, s[8:11], s27 offen offset:32
    s_add_u32 s27, s27, 2048
    buffer_load_ushort v159, v227, s[8:11], s27 offen offset:32
    s_add_u32 s27, s27, 2048
    buffer_load_ushort v160, v227, s[8:11], s27 offen offset:32
    s_add_u32 s27, s27, 2048
    buffer_load_ushort v161, v227, s[8:11], s27 offen offset:32
    s_add_u32 s27, s27, 2048
    buffer_load_ushort v162, v227, s[8:11], s27 offen offset:32
    s_add_u32 s27, s27, 2048
    buffer_load_ushort v163, v227, s[8:11], s27 offen offset:32
    s_add_u32 s27, s27, 2048
    s_add_u32 s27, s27, 49152
    s_waitcnt vmcnt(0)
    v_lshl_or_b32 v116, v133, 16, v132
    v_lshl_or_b32 v117, v135, 16, v134
    v_lshl_or_b32 v118, v137, 16, v136
    v_lshl_or_b32 v119, v139, 16, v138
    v_lshl_or_b32 v120, v141, 16, v140
    v_lshl_or_b32 v121, v143, 16, v142
    v_lshl_or_b32 v122, v145, 16, v144
    v_lshl_or_b32 v123, v147, 16, v146
    v_lshl_or_b32 v124, v149, 16, v148
    v_lshl_or_b32 v125, v151, 16, v150
    v_lshl_or_b32 v126, v153, 16, v152
    v_lshl_or_b32 v127, v155, 16, v154
    v_lshl_or_b32 v128, v157, 16, v156
    v_lshl_or_b32 v129, v159, 16, v158
    v_lshl_or_b32 v130, v161, 16, v160
    v_lshl_or_b32 v131, v163, 16, v162
    v_and_b32 v227, 7, v224
    v_lshl_add_u32 v228, v226, 3, v227
    v_lshlrev_b32 v228, 5, v228
    s_lshl_b32 s24, s3, 13
    v_add_u32 v231, s24, v228
    s_mul_i32 s24, s20, 3
    s_add_u32 s24, s24, s3
    s_lshl_b32 s24, s24, 12
    s_lshl_b32 s25, s21, 6
    s_add_u32 s24, s24, s25
    v_lshlrev_b32 v228, 9, v227
    v_lshl_add_u32 v228, v226, 4, v228
    v_add_u32 v232, s24, v228
    s_mul_i32 s24, s20, 12288
    s_mul_i32 s25, s3, 3072
    s_add_u32 s24, s24, s25
    v_lshlrev_b32 v228, 4, v224
    v_add_u32 v233, s24, v228
    s_lshl_b32 s24, s20, 8
    s_lshl_b32 s25, s21, 5
    s_add_u32 s24, s24, s25
    s_sub_u32 s25, s3, 1
    s_lshl_b32 s25, s25, 13
    s_add_u32 s24, s24, s25
    v_lshlrev_b32 v228, 14, v227
    v_lshl_add_u32 v228, v226, 3, v228
    v_add_u32 v243, s24, v228
    s_mul_i32 s24, s3, 3072
    v_lshlrev_b32 v228, 4, v224
    v_add_u32 v228, s24, v228
    v_add_u32 v244, 34816, v228
    v_lshrrev_b32 v228, 5, v224
    v_mul_u32_u24 v228, 272, v228
    v_and_b32 v229, 31, v224
    v_lshl_add_u32 v234, v229, 3, v228
    v_mul_u32_u24 v228, 272, v225
    v_lshl_add_u32 v235, v226, 4, v228
    v_lshrrev_b32 v228, 2, v225
    v_lshl_add_u32 v228, v226, 2, v228
    v_mul_u32_u24 v228, 272, v228
    v_and_b32 v229, 3, v224
    v_lshl_add_u32 v228, v229, 3, v228
    s_lshl_b32 s24, s3, 6
    v_add_u32 v228, s24, v228
    v_add_u32 v237, 13056, v228
    v_mul_u32_u24 v228, 272, v225
    v_lshl_add_u32 v228, v226, 3, v228
    v_add_u32 v228, s24, v228
    v_add_u32 v238, 30464, v228
    s_lshl_b32 s24, s20, 16
    s_lshl_b32 s25, s21, 13
    s_add_u32 s24, s24, s25
    s_lshl_b32 s25, s3, 11
    s_add_u32 s24, s24, s25
    v_lshl_add_u32 v228, v226, 3, v227
    v_lshlrev_b32 v228, 5, v228
    v_add_u32 v240, s24, v228
    s_lshl_b32 s24, s2, 8
    v_lshlrev_b32 v228, 16, v226
    v_lshl_add_u32 v228, v225, 4, v228
    v_add_u32 v241, s24, v228
    s_lshr_b32 s24, s2, 1
    s_lshl_b32 s24, s24, 8
    s_and_b32 s25, s2, 1
    s_lshl_b32 s25, s25, 4
    s_add_u32 s24, s24, s25
    v_lshrrev_b32 v228, 1, v225
    v_lshlrev_b32 v228, 5, v228
    v_and_b32 v229, 1, v225
    v_lshl_add_u32 v228, v229, 3, v228
    v_add_u32 v242, s24, v228
    v_lshrrev_b32 v228, 3, v0
    s_mov_b32 s24, 24576
    v_mul_lo_u32 v229, v228, s24
    v_and_b32 v230, 7, v0
    v_lshl_add_u32 v229, v230, 4, v229
    s_lshl_b32 s24, s20, 8
    s_add_u32 s24, s24, 12591104
    v_add_u32 v245, s24, v229
    v_mul_u32_u24 v229, 272, v228
    v_lshl_add_u32 v246, v230, 4, v229
    v_mov_b32 v132, 0
    v_mov_b32 v133, 0
    v_mov_b32 v134, 0
    v_mov_b32 v135, 0
    v_lshlrev_b32 v228, 4, v0
    ds_write_b128 v228, v[132:135] offset:0
    ds_write_b128 v228, v[132:135] offset:4096
    ds_write_b128 v228, v[132:135] offset:8192
    ds_write_b128 v228, v[132:135] offset:12288
    ds_write_b128 v228, v[132:135] offset:16384
    ds_write_b128 v228, v[132:135] offset:20480
    ds_write_b128 v228, v[132:135] offset:24576
    ds_write_b128 v228, v[132:135] offset:28672
    ds_write_b128 v228, v[132:135] offset:32768
    s_waitcnt lgkmcnt(0)
    s_barrier
    s_mov_b32 s22, 0
    s_mul_i32 s28, s22, 786432
    buffer_load_dwordx4 v[208:211], v245, s[4:7], s28 offen offset:0
    buffer_load_dwordx4 v[212:215], v245, s[4:7], s28 offen offset:128
    s_add_u32 s28, s28, 8192
    buffer_load_dwordx4 v[216:219], v245, s[4:7], s28 offen offset:0
    buffer_load_dwordx4 v[220:223], v245, s[4:7], s28 offen offset:128
rec_kernel_step1:
    s_add_u32 s23, s22, 1
    s_and_b32 s29, s22, 1
    s_cmp_lg_u32 s22, 0
    s_cbranch_scc1 rec_kernel_poll_mem
    s_mov_b32 s8, s48
    s_and_b32 s9, s49, 0xffff
    s_mov_b32 s10, 0x4000
    s_mov_b32 s11, 0x00020000
    v_and_b32 v227, 7, v224
    v_lshlrev_b32 v227, 11, v227
    v_lshl_add_u32 v227, v226, 4, v227
    s_lshl_b32 s24, s3, 9
    buffer_load_dwordx4 v[132:135], v227, s[8:11], s24 offen offset:0
    buffer_load_dwordx4 v[136:139], v227, s[8:11], s24 offen offset:64
    buffer_load_dwordx4 v[140:143], v227, s[8:11], s24 offen offset:128
    buffer_load_dwordx4 v[144:147], v227, s[8:11], s24 offen offset:192
    buffer_load_dwordx4 v[148:151], v227, s[8:11], s24 offen offset:256
    buffer_load_dwordx4 v[152:155], v227, s[8:11], s24 offen offset:320
    buffer_load_dwordx4 v[156:159], v227, s[8:11], s24 offen offset:384
    buffer_load_dwordx4 v[160:163], v227, s[8:11], s24 offen offset:448
    s_waitcnt vmcnt(0)
    s_branch rec_kernel_havemem2
rec_kernel_poll_mem:
    s_lshl_b32 s24, s29, 15
    s_add_u32 s24, s24, 105644032
    s_mov_b32 s30, 0
    s_cmp_lg_u32 s3, 0
    s_cbranch_scc1 rec_kernel_nopp4
rec_kernel_prepoll3:
    s_add_u32 s25, s24, 4096
    buffer_load_dwordx4 v[132:135], v231, s[4:7], s25 offen offset:3088 sc0 sc1
    s_waitcnt vmcnt(0)
    v_xor_b32 v227, s22, v133
    v_cmp_ne_u32 vcc, 0, v227
    s_add_u32 s30, s30, 1
    s_cmp_ge_u32 s30, 400000
    s_cbranch_scc1 rec_kernel_end
    s_cbranch_vccnz rec_kernel_prepoll3
rec_kernel_nopp4:
    s_barrier
rec_kernel_pollmem5:
    s_add_u32 s25, s24, 4096
    buffer_load_dwordx4 v[132:135], v231, s[4:7], s24 offen offset:0 sc0 sc1
    buffer_load_dwordx4 v[136:139], v231, s[4:7], s24 offen offset:16 sc0 sc1
    buffer_load_dwordx4 v[140:143], v231, s[4:7], s24 offen offset:1024 sc0 sc1
    buffer_load_dwordx4 v[144:147], v231, s[4:7], s24 offen offset:1040 sc0 sc1
    buffer_load_dwordx4 v[148:151], v231, s[4:7], s24 offen offset:2048 sc0 sc1
    buffer_load_dwordx4 v[152:155], v231, s[4:7], s24 offen offset:2064 sc0 sc1
    buffer_load_dwordx4 v[156:159], v231, s[4:7], s24 offen offset:3072 sc0 sc1
    buffer_load_dwordx4 v[160:163], v231, s[4:7], s24 offen offset:3088 sc0 sc1
    buffer_load_dwordx4 v[164:167], v231, s[4:7], s25 offen offset:0 sc0 sc1
    buffer_load_dwordx4 v[168:171], v231, s[4:7], s25 offen offset:16 sc0 sc1
    buffer_load_dwordx4 v[172:175], v231, s[4:7], s25 offen offset:1024 sc0 sc1
    buffer_load_dwordx4 v[176:179], v231, s[4:7], s25 offen offset:1040 sc0 sc1
    buffer_load_dwordx4 v[180:183], v231, s[4:7], s25 offen offset:2048 sc0 sc1
    buffer_load_dwordx4 v[184:187], v231, s[4:7], s25 offen offset:2064 sc0 sc1
    buffer_load_dwordx4 v[188:191], v231, s[4:7], s25 offen offset:3072 sc0 sc1
    buffer_load_dwordx4 v[192:195], v231, s[4:7], s25 offen offset:3088 sc0 sc1
    s_waitcnt vmcnt(0)
    v_xor_b32 v227, s22, v133
    v_xor_b32 v228, s22, v135
    v_xor_b32 v229, s22, v137
    v_xor_b32 v230, s22, v139
    v_or3_b32 v227, v227, v229, v230
    v_xor_b32 v229, s22, v141
    v_xor_b32 v230, s22, v143
    v_or3_b32 v227, v227, v229, v230
    v_xor_b32 v229, s22, v145
    v_xor_b32 v230, s22, v147
    v_or3_b32 v227, v227, v229, v230
    v_xor_b32 v229, s22, v149
    v_xor_b32 v230, s22, v151
    v_or3_b32 v227, v227, v229, v230
    v_xor_b32 v229, s22, v153
    v_xor_b32 v230, s22, v155
    v_or3_b32 v227, v227, v229, v230
    v_xor_b32 v229, s22, v157
    v_xor_b32 v230, s22, v159
    v_or3_b32 v227, v227, v229, v230
    v_xor_b32 v229, s22, v161
    v_xor_b32 v230, s22, v163
    v_or3_b32 v227, v227, v229, v230
    v_xor_b32 v229, s22, v165
    v_xor_b32 v230, s22, v167
    v_or3_b32 v227, v227, v229, v230
    v_xor_b32 v229, s22, v169
    v_xor_b32 v230, s22, v171
    v_or3_b32 v227, v227, v229, v230
    v_xor_b32 v229, s22, v173
    v_xor_b32 v230, s22, v175
    v_or3_b32 v227, v227, v229, v230
    v_xor_b32 v229, s22, v177
    v_xor_b32 v230, s22, v179
    v_or3_b32 v227, v227, v229, v230
    v_xor_b32 v229, s22, v181
    v_xor_b32 v230, s22, v183
    v_or3_b32 v227, v227, v229, v230
    v_xor_b32 v229, s22, v185
    v_xor_b32 v230, s22, v187
    v_or3_b32 v227, v227, v229, v230
    v_xor_b32 v229, s22, v189
    v_xor_b32 v230, s22, v191
    v_or3_b32 v227, v227, v229, v230
    v_xor_b32 v229, s22, v193
    v_xor_b32 v230, s22, v195
    v_or3_b32 v227, v227, v229, v230
    v_or_b32 v227, v227, v228
    v_cmp_ne_u32 vcc, 0, v227
    s_add_u32 s30, s30, 1
    s_cmp_ge_u32 s30, 400000
    s_cbranch_scc1 rec_kernel_end
    s_cbranch_vccz rec_kernel_ok6
    s_branch rec_kernel_pollmem5
rec_kernel_ok6:
    v_mov_b32 v132, v132
    v_mov_b32 v133, v134
    v_mov_b32 v134, v136
    v_mov_b32 v135, v138
    v_mov_b32 v136, v140
    v_mov_b32 v137, v142
    v_mov_b32 v138, v144
    v_mov_b32 v139, v146
    v_mov_b32 v140, v148
    v_mov_b32 v141, v150
    v_mov_b32 v142, v152
    v_mov_b32 v143, v154
    v_mov_b32 v144, v156
    v_mov_b32 v145, v158
    v_mov_b32 v146, v160
    v_mov_b32 v147, v162
    v_mov_b32 v148, v164
    v_mov_b32 v149, v166
    v_mov_b32 v150, v168
    v_mov_b32 v151, v170
    v_mov_b32 v152, v172
    v_mov_b32 v153, v174
    v_mov_b32 v154, v176
    v_mov_b32 v155, v178
    v_mov_b32 v156, v180
    v_mov_b32 v157, v182
    v_mov_b32 v158, v184
    v_mov_b32 v159, v186
    v_mov_b32 v160, v188
    v_mov_b32 v161, v190
    v_mov_b32 v162, v192
    v_mov_b32 v163, v194
rec_kernel_havemem2:
    s_waitcnt vmcnt(0)
    ds_write_b128 v246, v[208:211] offset:0
    ds_write_b128 v246, v[216:219] offset:13056
    ds_write_b128 v246, v[212:215] offset:128
    ds_write_b128 v246, v[220:223] offset:13184
    v_mov_b32 v196, 0
    v_mov_b32 v197, 0
    v_mov_b32 v198, 0
    v_mov_b32 v199, 0
    v_mov_b32 v200, 0
    v_mov_b32 v201, 0
    v_mov_b32 v202, 0
    v_mov_b32 v203, 0
    v_mov_b32 v204, 0
    v_mov_b32 v205, 0
    v_mov_b32 v206, 0
    v_mov_b32 v207, 0
    s_nop 1
    v_mfma_f32_16x16x32_bf16 v[196:199], v[4:7], v[132:135], v[196:199]
    v_mfma_f32_16x16x32_bf16 v[200:203], v[8:11], v[132:135], v[200:203]
    v_mfma_f32_16x16x32_bf16 v[204:207], v[12:15], v[132:135], v[204:207]
    v_mfma_f32_16x16x32_bf16 v[196:199], v[16:19], v[136:139], v[196:199]
    v_mfma_f32_16x16x32_bf16 v[200:203], v[20:23], v[136:139], v[200:203]
    v_mfma_f32_16x16x32_bf16 v[204:207], v[24:27], v[136:139], v[204:207]
    v_mfma_f32_16x16x32_bf16 v[196:199], v[28:31], v[140:143], v[196:199]
    v_mfma_f32_16x16x32_bf16 v[200:203], v[32:35], v[140:143], v[200:203]
    v_mfma_f32_16x16x32_bf16 v[204:207], v[36:39], v[140:143], v[204:207]
    v_mfma_f32_16x16x32_bf16 v[196:199], v[40:43], v[144:147], v[196:199]
    v_mfma_f32_16x16x32_bf16 v[200:203], v[44:47], v[144:147], v[200:203]
    v_mfma_f32_16x16x32_bf16 v[204:207], v[48:51], v[144:147], v[204:207]
    v_mfma_f32_16x16x32_bf16 v[196:199], v[52:55], v[148:151], v[196:199]
    v_mfma_f32_16x16x32_bf16 v[200:203], v[56:59], v[148:151], v[200:203]
    v_mfma_f32_16x16x32_bf16 v[204:207], v[60:63], v[148:151], v[204:207]
    v_mfma_f32_16x16x32_bf16 v[196:199], v[64:67], v[152:155], v[196:199]
    v_mfma_f32_16x16x32_bf16 v[200:203], v[68:71], v[152:155], v[200:203]
    v_mfma_f32_16x16x32_bf16 v[204:207], v[72:75], v[152:155], v[204:207]
    v_mfma_f32_16x16x32_bf16 v[196:199], v[76:79], v[156:159], v[196:199]
    v_mfma_f32_16x16x32_bf16 v[200:203], v[80:83], v[156:159], v[200:203]
    v_mfma_f32_16x16x32_bf16 v[204:207], v[84:87], v[156:159], v[204:207]
    v_mfma_f32_16x16x32_bf16 v[196:199], v[88:91], v[160:163], v[196:199]
    v_mfma_f32_16x16x32_bf16 v[200:203], v[92:95], v[160:163], v[200:203]
    v_mfma_f32_16x16x32_bf16 v[204:207], v[96:99], v[160:163], v[204:207]
    s_nop 7
    s_nop 3
    ds_write_b128 v244, v[196:199] offset:0
    ds_write_b128 v244, v[200:203] offset:1024
    ds_write_b128 v244, v[204:207] offset:2048
    s_waitcnt lgkmcnt(0)
    s_barrier
    s_cmp_ge_u32 s3, 3
    s_cbranch_scc1 rec_kernel_nopub7
    s_lshl_b32 s24, s3, 10
    v_lshlrev_b32 v227, 4, v224
    v_add_u32 v227, s24, v227
    ds_read_b128 v[132:135], v227 offset:34816
    ds_read_b128 v[136:139], v227 offset:37888
    ds_read_b128 v[140:143], v227 offset:40960
    ds_read_b128 v[144:147], v227 offset:44032
    s_waitcnt lgkmcnt(0)
    v_add_f32 v132, v132, v136
    v_add_f32 v140, v140, v144
    v_add_f32 v133, v133, v137
    v_add_f32 v141, v141, v145
    v_add_f32 v134, v134, v138
    v_add_f32 v142, v142, v146
    v_add_f32 v135, v135, v139
    v_add_f32 v143, v143, v147
    v_add_f32 v132, v132, v140
    v_add_f32 v133, v133, v141
    v_add_f32 v134, v134, v142
    v_add_f32 v135, v135, v143
    v_cvt_pk_bf16_f32 v148, v132, v133
    v_cvt_pk_bf16_f32 v150, v134, v135
    v_mov_b32 v149, s23
    v_mov_b32 v151, s23
    s_mul_i32 s24, s29, 393216
    s_add_u32 s24, s24, 100663296
    buffer_store_dwordx4 v[148:151], v232, s[4:7], s24 offen sc0 sc1
    s_cmp_eq_u32 s3, 0
    s_cbranch_scc1 rec_kernel_nokv8
    v_mov_b32 v149, v150
    s_lshl_b32 s24, s22, 17
    s_add_u32 s24, s24, 83886080
    buffer_store_dwordx2 v[148:149], v243, s[4:7], s24 offen
rec_kernel_nokv8:
rec_kernel_nopub7:
    s_cmp_eq_u32 s22, 63
    s_cbranch_scc1 rec_kernel_end
    s_mul_i32 s24, s29, 393216
    s_add_u32 s24, s24, 100663296
    s_mov_b32 s30, 0
rec_kernel_pollx9:
    buffer_load_dwordx4 v[132:135], v233, s[4:7], s24 offen offset:0 sc0 sc1
    buffer_load_dwordx4 v[136:139], v233, s[4:7], s24 offen offset:1024 sc0 sc1
    buffer_load_dwordx4 v[140:143], v233, s[4:7], s24 offen offset:2048 sc0 sc1
    s_waitcnt vmcnt(0)
    v_xor_b32 v227, s23, v133
    v_xor_b32 v228, s23, v135
    v_xor_b32 v229, s23, v137
    v_xor_b32 v230, s23, v139
    v_or3_b32 v227, v227, v229, v230
    v_xor_b32 v229, s23, v141
    v_xor_b32 v230, s23, v143
    v_or3_b32 v227, v227, v229, v230
    v_or_b32 v227, v227, v228
    v_cmp_ne_u32 vcc, 0, v227
    s_add_u32 s30, s30, 1
    s_cmp_ge_u32 s30, 400000
    s_cbranch_scc1 rec_kernel_end
    s_cbranch_vccz rec_kernel_ok10
    s_branch rec_kernel_pollx9
rec_kernel_ok10:
    v_mov_b32 v133, v134
    v_mov_b32 v137, v138
    v_mov_b32 v141, v142
    s_mul_i32 s24, s3, 3
    s_add_u32 s24, s24, 0
    s_lshr_b32 s25, s24, 2
    s_and_b32 s24, s24, 3
    s_mul_i32 s24, s24, 544
    s_mov_b32 s26, 26112
    s_cmp_eq_u32 s25, 1
    s_cselect_b32 s26, 8704, s26
    s_cmp_eq_u32 s25, 2
    s_cselect_b32 s26, 21760, s26
    s_add_u32 s24, s24, s26
    v_add_u32 v227, s24, v234
    ds_write_b64 v227, v[132:133]
    s_mul_i32 s24, s3, 3
    s_add_u32 s24, s24, 1
    s_lshr_b32 s25, s24, 2
    s_and_b32 s24, s24, 3
    s_mul_i32 s24, s24, 544
    s_mov_b32 s26, 26112
    s_cmp_eq_u32 s25, 1
    s_cselect_b32 s26, 8704, s26
    s_cmp_eq_u32 s25, 2
    s_cselect_b32 s26, 21760, s26
    s_add_u32 s24, s24, s26
    v_add_u32 v227, s24, v234
    ds_write_b64 v227, v[136:137]
    s_mul_i32 s24, s3, 3
    s_add_u32 s24, s24, 2
    s_lshr_b32 s25, s24, 2
    s_and_b32 s24, s24, 3
    s_mul_i32 s24, s24, 544
    s_mov_b32 s26, 26112
    s_cmp_eq_u32 s25, 1
    s_cselect_b32 s26, 8704, s26
    s_cmp_eq_u32 s25, 2
    s_cselect_b32 s26, 21760, s26
    s_add_u32 s24, s24, s26
    v_add_u32 v227, s24, v234
    ds_write_b64 v227, v[140:141]
    s_waitcnt lgkmcnt(0)
    s_barrier
    s_add_u32 s31, s22, 1
    s_mul_i32 s28, s31, 786432
    buffer_load_dwordx4 v[208:211], v245, s[4:7], s28 offen offset:0
    buffer_load_dwordx4 v[212:215], v245, s[4:7], s28 offen offset:128
    s_add_u32 s28, s28, 8192
    buffer_load_dwordx4 v[216:219], v245, s[4:7], s28 offen offset:0
    buffer_load_dwordx4 v[220:223], v245, s[4:7], s28 offen offset:128
    ds_read_b128 v[160:163], v235 offset:26112
    ds_read_b128 v[164:167], v235 offset:26176
    ds_read_b128 v[168:171], v235 offset:26240
    ds_read_b128 v[172:175], v235 offset:26304
    v_mov_b32 v132, 0
    v_mov_b32 v133, 0
    v_mov_b32 v134, 0
    v_mov_b32 v135, 0
    v_mov_b32 v136, 0
    v_mov_b32 v137, 0
    v_mov_b32 v138, 0
    v_mov_b32 v139, 0
    v_mov_b32 v140, 0
    v_mov_b32 v141, 0
    v_mov_b32 v142, 0
    v_mov_b32 v143, 0
    ds_read_b128 v[144:147], v235 offset:0
    ds_read_b128 v[148:151], v235 offset:64
    ds_read_b128 v[152:155], v235 offset:128
    ds_read_b128 v[156:159], v235 offset:192
    s_waitcnt lgkmcnt(0)
    v_mfma_f32_16x16x32_bf16 v[132:135], v[144:147], v[160:163], v[132:135]
    v_mfma_f32_16x16x32_bf16 v[132:135], v[148:151], v[164:167], v[132:135]
    v_mfma_f32_16x16x32_bf16 v[132:135], v[152:155], v[168:171], v[132:135]
    v_mfma_f32_16x16x32_bf16 v[132:135], v[156:159], v[172:175], v[132:135]
    ds_read_b128 v[144:147], v235 offset:4352
    ds_read_b128 v[148:151], v235 offset:4416
    ds_read_b128 v[152:155], v235 offset:4480
    ds_read_b128 v[156:159], v235 offset:4544
    s_waitcnt lgkmcnt(0)
    v_mfma_f32_16x16x32_bf16 v[136:139], v[144:147], v[160:163], v[136:139]
    v_mfma_f32_16x16x32_bf16 v[136:139], v[148:151], v[164:167], v[136:139]
    v_mfma_f32_16x16x32_bf16 v[136:139], v[152:155], v[168:171], v[136:139]
    v_mfma_f32_16x16x32_bf16 v[136:139], v[156:159], v[172:175], v[136:139]
    ds_read_b128 v[144:147], v235 offset:8704
    ds_read_b128 v[148:151], v235 offset:8768
    ds_read_b128 v[152:155], v235 offset:8832
    ds_read_b128 v[156:159], v235 offset:8896
    s_waitcnt lgkmcnt(0)
    v_mfma_f32_16x16x32_bf16 v[140:143], v[144:147], v[160:163], v[140:143]
    v_mfma_f32_16x16x32_bf16 v[140:143], v[148:151], v[164:167], v[140:143]
    v_mfma_f32_16x16x32_bf16 v[140:143], v[152:155], v[168:171], v[140:143]
    v_mfma_f32_16x16x32_bf16 v[140:143], v[156:159], v[172:175], v[140:143]
    s_nop 7
    s_nop 3
    s_mov_b32 s24, 0x3db504f3
    v_cvt_pk_bf16_f32 v132, v132, v132
    v_lshlrev_b32 v132, 16, v132
    v_mul_f32 v132, s24, v132
    v_cvt_pk_bf16_f32 v132, v132, v132
    v_lshlrev_b32 v132, 16, v132
    v_cvt_pk_bf16_f32 v133, v133, v133
    v_lshlrev_b32 v133, 16, v133
    v_mul_f32 v133, s24, v133
    v_cvt_pk_bf16_f32 v133, v133, v133
    v_lshlrev_b32 v133, 16, v133
    v_cvt_pk_bf16_f32 v134, v134, v134
    v_lshlrev_b32 v134, 16, v134
    v_mul_f32 v134, s24, v134
    v_cvt_pk_bf16_f32 v134, v134, v134
    v_lshlrev_b32 v134, 16, v134
    v_cvt_pk_bf16_f32 v135, v135, v135
    v_lshlrev_b32 v135, 16, v135
    v_mul_f32 v135, s24, v135
    v_cvt_pk_bf16_f32 v135, v135, v135
    v_lshlrev_b32 v135, 16, v135
    v_cvt_pk_bf16_f32 v136, v136, v136
    v_lshlrev_b32 v136, 16, v136
    v_mul_f32 v136, s24, v136
    v_cvt_pk_bf16_f32 v136, v136, v136
    v_lshlrev_b32 v136, 16, v136
    v_cvt_pk_bf16_f32 v137, v137, v137
    v_lshlrev_b32 v137, 16, v137
    v_mul_f32 v137, s24, v137
    v_cvt_pk_bf16_f32 v137, v137, v137
    v_lshlrev_b32 v137, 16, v137
    v_cvt_pk_bf16_f32 v138, v138, v138
    v_lshlrev_b32 v138, 16, v138
    v_mul_f32 v138, s24, v138
    v_cvt_pk_bf16_f32 v138, v138, v138
    v_lshlrev_b32 v138, 16, v138
    v_cvt_pk_bf16_f32 v139, v139, v139
    v_lshlrev_b32 v139, 16, v139
    v_mul_f32 v139, s24, v139
    v_cvt_pk_bf16_f32 v139, v139, v139
    v_lshlrev_b32 v139, 16, v139
    v_cvt_pk_bf16_f32 v140, v140, v140
    v_lshlrev_b32 v140, 16, v140
    v_mul_f32 v140, s24, v140
    v_cvt_pk_bf16_f32 v140, v140, v140
    v_lshlrev_b32 v140, 16, v140
    v_cvt_pk_bf16_f32 v141, v141, v141
    v_lshlrev_b32 v141, 16, v141
    v_mul_f32 v141, s24, v141
    v_cvt_pk_bf16_f32 v141, v141, v141
    v_lshlrev_b32 v141, 16, v141
    v_cvt_pk_bf16_f32 v142, v142, v142
    v_lshlrev_b32 v142, 16, v142
    v_mul_f32 v142, s24, v142
    v_cvt_pk_bf16_f32 v142, v142, v142
    v_lshlrev_b32 v142, 16, v142
    v_cvt_pk_bf16_f32 v143, v143, v143
    v_lshlrev_b32 v143, 16, v143
    v_mul_f32 v143, s24, v143
    v_cvt_pk_bf16_f32 v143, v143, v143
    v_lshlrev_b32 v143, 16, v143
    v_cmp_le_u32 vcc, 2, v226
    s_mov_b32 s24, 0xf149f2ca
    v_mov_b32 v227, s24
    v_cndmask_b32 v140, v140, v227, vcc
    v_mov_b32 v227, s24
    v_cndmask_b32 v141, v141, v227, vcc
    v_mov_b32 v227, s24
    v_cndmask_b32 v142, v142, v227, vcc
    v_mov_b32 v227, s24
    v_cndmask_b32 v143, v143, v227, vcc
    v_max3_f32 v227, v132, v133, v134
    v_max3_f32 v227, v227, v135, v136
    v_max3_f32 v227, v227, v137, v138
    v_max3_f32 v227, v227, v139, v140
    v_max3_f32 v227, v227, v141, v142
    v_max_f32 v227, v227, v143
    v_xor_b32 v228, 16, v224
    v_lshlrev_b32 v228, 2, v228
    ds_bpermute_b32 v229, v228, v227
    s_waitcnt lgkmcnt(0)
    v_max_f32 v227, v227, v229
    v_xor_b32 v228, 32, v224
    v_lshlrev_b32 v228, 2, v228
    ds_bpermute_b32 v229, v228, v227
    s_waitcnt lgkmcnt(0)
    v_max_f32 v227, v227, v229
    s_mov_b32 s24, 0x3fb8aa3b
    v_sub_f32 v132, v132, v227
    v_mul_f32 v132, s24, v132
    v_exp_f32 v132, v132
    v_sub_f32 v133, v133, v227
    v_mul_f32 v133, s24, v133
    v_exp_f32 v133, v133
    v_sub_f32 v134, v134, v227
    v_mul_f32 v134, s24, v134
    v_exp_f32 v134, v134
    v_sub_f32 v135, v135, v227
    v_mul_f32 v135, s24, v135
    v_exp_f32 v135, v135
    v_sub_f32 v136, v136, v227
    v_mul_f32 v136, s24, v136
    v_exp_f32 v136, v136
    v_sub_f32 v137, v137, v227
    v_mul_f32 v137, s24, v137
    v_exp_f32 v137, v137
    v_sub_f32 v138, v138, v227
    v_mul_f32 v138, s24, v138
    v_exp_f32 v138, v138
    v_sub_f32 v139, v139, v227
    v_mul_f32 v139, s24, v139
    v_exp_f32 v139, v139
    v_sub_f32 v140, v140, v227
    v_mul_f32 v140, s24, v140
    v_exp_f32 v140, v140
    v_sub_f32 v141, v141, v227
    v_mul_f32 v141, s24, v141
    v_exp_f32 v141, v141
    v_sub_f32 v142, v142, v227
    v_mul_f32 v142, s24, v142
    v_exp_f32 v142, v142
    v_sub_f32 v143, v143, v227
    v_mul_f32 v143, s24, v143
    v_exp_f32 v143, v143
    s_nop 0
    v_add_f32 v227, v132, v133
    v_add_f32 v227, v227, v134
    v_add_f32 v227, v227, v135
    v_add_f32 v227, v227, v136
    v_add_f32 v227, v227, v137
    v_add_f32 v227, v227, v138
    v_add_f32 v227, v227, v139
    v_add_f32 v227, v227, v140
    v_add_f32 v227, v227, v141
    v_add_f32 v227, v227, v142
    v_add_f32 v227, v227, v143
    v_xor_b32 v228, 16, v224
    v_lshlrev_b32 v228, 2, v228
    ds_bpermute_b32 v229, v228, v227
    s_waitcnt lgkmcnt(0)
    v_add_f32 v227, v227, v229
    v_xor_b32 v228, 32, v224
    v_lshlrev_b32 v228, 2, v228
    ds_bpermute_b32 v229, v228, v227
    s_waitcnt lgkmcnt(0)
    v_add_f32 v227, v227, v229
    v_rcp_f32 v227, v227
    s_nop 0
    v_mul_f32 v132, v132, v227
    v_mul_f32 v133, v133, v227
    v_mul_f32 v134, v134, v227
    v_mul_f32 v135, v135, v227
    v_mul_f32 v136, v136, v227
    v_mul_f32 v137, v137, v227
    v_mul_f32 v138, v138, v227
    v_mul_f32 v139, v139, v227
    v_mul_f32 v140, v140, v227
    v_mul_f32 v141, v141, v227
    v_mul_f32 v142, v142, v227
    v_mul_f32 v143, v143, v227
    v_cvt_pk_bf16_f32 v144, v132, v133
    v_cvt_pk_bf16_f32 v145, v134, v135
    v_cvt_pk_bf16_f32 v146, v136, v137
    v_cvt_pk_bf16_f32 v147, v138, v139
    v_cvt_pk_bf16_f32 v148, v140, v141
    v_cvt_pk_bf16_f32 v149, v142, v143
    v_mov_b32 v150, 0
    v_mov_b32 v151, 0
    v_mov_b32 v132, 0
    v_mov_b32 v133, 0
    v_mov_b32 v134, 0
    v_mov_b32 v135, 0
    v_mov_b32 v136, 0
    v_mov_b32 v137, 0
    v_mov_b32 v138, 0
    v_mov_b32 v139, 0
    ds_read_b64_tr_b16 v[160:161], v237 offset:0
    ds_read_b64_tr_b16 v[162:163], v237 offset:4352
    ds_read_b64_tr_b16 v[164:165], v237 offset:8704
    ds_read_b64_tr_b16 v[166:167], v237 offset:8704
    s_waitcnt lgkmcnt(0)
    v_mfma_f32_16x16x32_bf16 v[132:135], v[160:163], v[144:147], v[132:135]
    v_mfma_f32_16x16x32_bf16 v[132:135], v[164:167], v[148:151], v[132:135]
    ds_read_b64_tr_b16 v[160:161], v237 offset:32
    ds_read_b64_tr_b16 v[162:163], v237 offset:4384
    ds_read_b64_tr_b16 v[164:165], v237 offset:8736
    ds_read_b64_tr_b16 v[166:167], v237 offset:8736
    s_waitcnt lgkmcnt(0)
    v_mfma_f32_16x16x32_bf16 v[136:139], v[160:163], v[144:147], v[136:139]
    v_mfma_f32_16x16x32_bf16 v[136:139], v[164:167], v[148:151], v[136:139]
    s_nop 7
    s_nop 3
    v_cvt_pk_bf16_f32 v228, v132, v133
    v_cvt_pk_bf16_f32 v229, v134, v135
    ds_write_b64 v238, v[228:229] offset:0
    v_cvt_pk_bf16_f32 v228, v136, v137
    v_cvt_pk_bf16_f32 v229, v138, v139
    ds_write_b64 v238, v[228:229] offset:32
    s_waitcnt lgkmcnt(0)
    s_barrier
    ds_read_b128 v[164:167], v235 offset:30464
    ds_read_b128 v[168:171], v235 offset:30528
    ds_read_b128 v[172:175], v235 offset:30592
    ds_read_b128 v[176:179], v235 offset:30656
    v_mov_b32 v196, 0
    v_mov_b32 v197, 0
    v_mov_b32 v198, 0
    v_mov_b32 v199, 0
    v_mov_b32 v200, 0
    v_mov_b32 v201, 0
    v_mov_b32 v202, 0
    v_mov_b32 v203, 0
    s_waitcnt lgkmcnt(0)
    v_mfma_f32_16x16x32_bf16 v[196:199], v[100:103], v[164:167], v[196:199]
    v_mfma_f32_16x16x32_bf16 v[196:199], v[104:107], v[168:171], v[196:199]
    v_mfma_f32_16x16x32_bf16 v[196:199], v[108:111], v[172:175], v[196:199]
    v_mfma_f32_16x16x32_bf16 v[196:199], v[112:115], v[176:179], v[196:199]
    v_mfma_f32_16x16x32_bf16 v[200:203], v[116:119], v[164:167], v[200:203]
    v_mfma_f32_16x16x32_bf16 v[200:203], v[120:123], v[168:171], v[200:203]
    v_mfma_f32_16x16x32_bf16 v[200:203], v[124:127], v[172:175], v[200:203]
    v_mfma_f32_16x16x32_bf16 v[200:203], v[128:131], v[176:179], v[200:203]
    s_nop 7
    s_nop 3
    s_mul_i32 s24, s29, 2097152
    s_add_u32 s24, s24, 101449728
    v_cmp_gt_u32 vcc, 8, v225
    s_and_saveexec_b64 s[32:33], vcc
    v_mov_b32 v132, v196
    v_mov_b32 v133, s23
    v_mov_b32 v134, v197
    v_mov_b32 v135, s23
    v_mov_b32 v136, v198
    v_mov_b32 v137, s23
    v_mov_b32 v138, v199
    v_mov_b32 v139, s23
    buffer_store_dwordx4 v[132:135], v240, s[4:7], s24 offen offset:0 sc0 sc1
    buffer_store_dwordx4 v[136:139], v240, s[4:7], s24 offen offset:16 sc0 sc1
    s_nop 1
    v_mov_b32 v132, v200
    v_mov_b32 v133, s23
    v_mov_b32 v134, v201
    v_mov_b32 v135, s23
    v_mov_b32 v136, v202
    v_mov_b32 v137, s23
    v_mov_b32 v138, v203
    v_mov_b32 v139, s23
    buffer_store_dwordx4 v[132:135], v240, s[4:7], s24 offen offset:1024 sc0 sc1
    buffer_store_dwordx4 v[136:139], v240, s[4:7], s24 offen offset:1040 sc0 sc1
    s_nop 1
    s_mov_b64 exec, s[32:33]
    s_cmp_lg_u32 s3, 0
    s_cbranch_scc1 rec_kernel_nored11
    s_mov_b32 s30, 0
rec_kernel_pollp12:
    s_mov_b32 s25, s24
    buffer_load_dwordx4 v[132:135], v241, s[4:7], s25 offen sc0 sc1
    s_add_u32 s25, s25, 262144
    buffer_load_dwordx4 v[136:139], v241, s[4:7], s25 offen sc0 sc1
    s_add_u32 s25, s25, 262144
    buffer_load_dwordx4 v[140:143], v241, s[4:7], s25 offen sc0 sc1
    s_add_u32 s25, s25, 262144
    buffer_load_dwordx4 v[144:147], v241, s[4:7], s25 offen sc0 sc1
    s_add_u32 s25, s25, 262144
    buffer_load_dwordx4 v[148:151], v241, s[4:7], s25 offen sc0 sc1
    s_add_u32 s25, s25, 262144
    buffer_load_dwordx4 v[152:155], v241, s[4:7], s25 offen sc0 sc1
    s_add_u32 s25, s25, 262144
    buffer_load_dwordx4 v[156:159], v241, s[4:7], s25 offen sc0 sc1
    s_add_u32 s25, s25, 262144
    buffer_load_dwordx4 v[160:163], v241, s[4:7], s25 offen sc0 sc1
    s_add_u32 s25, s25, 262144
    s_waitcnt vmcnt(0)
    v_xor_b32 v227, s23, v133
    v_xor_b32 v228, s23, v135
    v_xor_b32 v229, s23, v137
    v_xor_b32 v230, s23, v139
    v_or3_b32 v227, v227, v229, v230
    v_xor_b32 v229, s23, v141
    v_xor_b32 v230, s23, v143
    v_or3_b32 v227, v227, v229, v230
    v_xor_b32 v229, s23, v145
    v_xor_b32 v230, s23, v147
    v_or3_b32 v227, v227, v229, v230
    v_xor_b32 v229, s23, v149
    v_xor_b32 v230, s23, v151
    v_or3_b32 v227, v227, v229, v230
    v_xor_b32 v229, s23, v153
    v_xor_b32 v230, s23, v155
    v_or3_b32 v227, v227, v229, v230
    v_xor_b32 v229, s23, v157
    v_xor_b32 v230, s23, v159
    v_or3_b32 v227, v227, v229, v230
    v_xor_b32 v229, s23, v161
    v_xor_b32 v230, s23, v163
    v_or3_b32 v227, v227, v229, v230
    v_or_b32 v227, v227, v228
    v_cmp_ne_u32 vcc, 0, v227
    s_add_u32 s30, s30, 1
    s_cmp_ge_u32 s30, 400000
    s_cbranch_scc1 rec_kernel_end
    s_cbranch_vccz rec_kernel_ok13
    s_branch rec_kernel_pollp12
rec_kernel_ok13:
    v_add_f32 v132, v132, v136
    v_add_f32 v134, v134, v138
    v_add_f32 v132, v132, v140
    v_add_f32 v134, v134, v142
    v_add_f32 v132, v132, v144
    v_add_f32 v134, v134, v146
    v_add_f32 v132, v132, v148
    v_add_f32 v134, v134, v150
    v_add_f32 v132, v132, v152
    v_add_f32 v134, v134, v154
    v_add_f32 v132, v132, v156
    v_add_f32 v134, v134, v158
    v_add_f32 v132, v132, v160
    v_add_f32 v134, v134, v162
    v_xor_b32 v228, 16, v224
    v_lshlrev_b32 v228, 2, v228
    ds_bpermute_b32 v229, v228, v132
    ds_bpermute_b32 v230, v228, v134
    s_waitcnt lgkmcnt(0)
    v_add_f32 v132, v132, v229
    v_add_f32 v134, v134, v230
    v_xor_b32 v228, 32, v224
    v_lshlrev_b32 v228, 2, v228
    ds_bpermute_b32 v229, v228, v132
    ds_bpermute_b32 v230, v228, v134
    s_waitcnt lgkmcnt(0)
    v_add_f32 v132, v132, v229
    v_add_f32 v134, v134, v230
    v_cvt_pk_bf16_f32 v132, v132, v134
    v_mov_b32 v133, s23
    s_xor_b32 s25, s29, 1
    s_lshl_b32 s25, s25, 15
    s_add_u32 s25, s25, 105644032
    v_cmp_gt_u32 vcc, 16, v224
    s_and_saveexec_b64 s[32:33], vcc
    buffer_store_dwordx2 v[132:133], v242, s[4:7], s25 offen sc0 sc1
    s_mov_b64 exec, s[32:33]
rec_kernel_nored11:
    s_barrier
    s_add_u32 s22, s22, 1
    s_branch rec_kernel_step1
rec_kernel_end:
    s_endpgm
.section .rodata,"a"
.p2align 6
.amdhsa_kernel rec_kernel
  .amdhsa_next_free_vgpr 248
  .amdhsa_next_free_sgpr 102
  .amdhsa_accum_offset 248
  .amdhsa_group_segment_fixed_size 0
  .amdhsa_kernarg_size 104
  .amdhsa_user_sgpr_count 2
  .amdhsa_user_sgpr_kernarg_segment_ptr 1
  .amdhsa_system_sgpr_workgroup_id_x 1
.end_amdhsa_kernel

.text
.globl attnA_kernel
.p2align 8
.type attnA_kernel,@function
attnA_kernel:
    s_cmp_ge_u32 s2, 1024
    s_cbranch_scc1 attnA_kernel_end
    s_load_dwordx2 s[64:65], s[0:1], 96
    v_and_b32 v1, 63, v0
    v_lshrrev_b32 v4, 6, v0
    s_nop 1
    v_readfirstlane_b32 s3, v4
    v_and_b32 v2, 15, v1
    v_lshrrev_b32 v3, 4, v1
    s_and_b32 s20, s2, 31
    s_lshr_b32 s21, s2, 5
    s_waitcnt lgkmcnt(0)
    s_mov_b32 s4, s64
    s_and_b32 s5, s65, 0xffff
    s_mov_b32 s6, 0x10000000
    s_mov_b32 s7, 0x00020000
    s_lshl_b32 s22, s21, 6
    s_lshl_b32 s23, s3, 4
    s_add_u32 s23, s23, s22
    s_mov_b32 s24, 6144
    v_mul_lo_u32 v9, v2, s24
    v_lshl_add_u32 v9, v3, 4, v9
    s_lshl_b32 s26, s20, 6
    s_mul_i32 s27, s23, 6144
    s_add_u32 s27, s27, s26
    buffer_load_dwordx4 v[12:15], v9, s[4:7], s27 offen
    v_lshrrev_b32 v4, 2, v0
    v_and_b32 v6, 3, v0
    v_mul_u32_u24 v8, 80, v4
    v_lshl_add_u32 v8, v6, 4, v8
    s_add_i32 s27, s22, -256
    v_add_u32 v7, s27, v4
    v_max_i32 v7, 0, v7
    v_mul_lo_u32 v7, v7, s24
    v_lshl_add_u32 v7, v6, 4, v7
    s_add_u32 s28, s26, 4096
    buffer_load_dwordx4 v[16:19], v7, s[4:7], s28 offen
    s_waitcnt vmcnt(0)
    ds_write_b128 v8, v[16:19] offset:0
    s_add_i32 s27, s22, -192
    v_add_u32 v7, s27, v4
    v_max_i32 v7, 0, v7
    v_mul_lo_u32 v7, v7, s24
    v_lshl_add_u32 v7, v6, 4, v7
    s_add_u32 s28, s26, 4096
    buffer_load_dwordx4 v[16:19], v7, s[4:7], s28 offen
    s_waitcnt vmcnt(0)
    ds_write_b128 v8, v[16:19] offset:5120
    s_add_i32 s27, s22, -128
    v_add_u32 v7, s27, v4
    v_max_i32 v7, 0, v7
    v_mul_lo_u32 v7, v7, s24
    v_lshl_add_u32 v7, v6, 4, v7
    s_add_u32 s28, s26, 4096
    buffer_load_dwordx4 v[16:19], v7, s[4:7], s28 offen
    s_waitcnt vmcnt(0)
    ds_write_b128 v8, v[16:19] offset:10240
    s_add_i32 s27, s22, -64
    v_add_u32 v7, s27, v4
    v_max_i32 v7, 0, v7
    v_mul_lo_u32 v7, v7, s24
    v_lshl_add_u32 v7, v6, 4, v7
    s_add_u32 s28, s26, 4096
    buffer_load_dwordx4 v[16:19], v7, s[4:7], s28 offen
    s_waitcnt vmcnt(0)
    ds_write_b128 v8, v[16:19] offset:15360
    s_add_i32 s27, s22, 0
    v_add_u32 v7, s27, v4
    v_max_i32 v7, 0, v7
    v_mul_lo_u32 v7, v7, s24
    v_lshl_add_u32 v7, v6, 4, v7
    s_add_u32 s28, s26, 4096
    buffer_load_dwordx4 v[16:19], v7, s[4:7], s28 offen
    s_waitcnt vmcnt(0)
    ds_write_b128 v8, v[16:19] offset:20480
    s_waitcnt lgkmcnt(0)
    s_barrier
    s_add_i32 s27, s23, -256
    v_add_u32 v7, s27, v2
    v_max_i32 v7, 0, v7
    v_mul_lo_u32 v7, v7, s24
    v_lshl_add_u32 v7, v3, 4, v7
    s_add_u32 s28, s26, 2048
    buffer_load_dwordx4 v[16:19], v7, s[4:7], s28 offen
    s_add_i32 s27, s23, -240
    v_add_u32 v7, s27, v2
    v_max_i32 v7, 0, v7
    v_mul_lo_u32 v7, v7, s24
    v_lshl_add_u32 v7, v3, 4, v7
    s_add_u32 s28, s26, 2048
    buffer_load_dwordx4 v[20:23], v7, s[4:7], s28 offen
    s_add_i32 s27, s23, -224
    v_add_u32 v7, s27, v2
    v_max_i32 v7, 0, v7
    v_mul_lo_u32 v7, v7, s24
    v_lshl_add_u32 v7, v3, 4, v7
    s_add_u32 s28, s26, 2048
    buffer_load_dwordx4 v[24:27], v7, s[4:7], s28 offen
    s_add_i32 s27, s23, -208
    v_add_u32 v7, s27, v2
    v_max_i32 v7, 0, v7
    v_mul_lo_u32 v7, v7, s24
    v_lshl_add_u32 v7, v3, 4, v7
    s_add_u32 s28, s26, 2048
    buffer_load_dwordx4 v[28:31], v7, s[4:7], s28 offen
    s_waitcnt vmcnt(0)
    v_mfma_f32_16x16x32_bf16 v[32:35], v[16:19], v[12:15], 0
    v_mfma_f32_16x16x32_bf16 v[36:39], v[20:23], v[12:15], 0
    v_mfma_f32_16x16x32_bf16 v[40:43], v[24:27], v[12:15], 0
    v_mfma_f32_16x16x32_bf16 v[44:47], v[28:31], v[12:15], 0
    s_add_i32 s27, s23, -192
    v_add_u32 v7, s27, v2
    v_max_i32 v7, 0, v7
    v_mul_lo_u32 v7, v7, s24
    v_lshl_add_u32 v7, v3, 4, v7
    s_add_u32 s28, s26, 2048
    buffer_load_dwordx4 v[16:19], v7, s[4:7], s28 offen
    s_add_i32 s27, s23, -176
    v_add_u32 v7, s27, v2
    v_max_i32 v7, 0, v7
    v_mul_lo_u32 v7, v7, s24
    v_lshl_add_u32 v7, v3, 4, v7
    s_add_u32 s28, s26, 2048
    buffer_load_dwordx4 v[20:23], v7, s[4:7], s28 offen
    s_add_i32 s27, s23, -160
    v_add_u32 v7, s27, v2
    v_max_i32 v7, 0, v7
    v_mul_lo_u32 v7, v7, s24
    v_lshl_add_u32 v7, v3, 4, v7
    s_add_u32 s28, s26, 2048
    buffer_load_dwordx4 v[24:27], v7, s[4:7], s28 offen
    s_add_i32 s27, s23, -144
    v_add_u32 v7, s27, v2
    v_max_i32 v7, 0, v7
    v_mul_lo_u32 v7, v7, s24
    v_lshl_add_u32 v7, v3, 4, v7
    s_add_u32 s28, s26, 2048
    buffer_load_dwordx4 v[28:31], v7, s[4:7], s28 offen
    s_waitcnt vmcnt(0)
    v_mfma_f32_16x16x32_bf16 v[48:51], v[16:19], v[12:15], 0
    v_mfma_f32_16x16x32_bf16 v[52:55], v[20:23], v[12:15], 0
    v_mfma_f32_16x16x32_bf16 v[56:59], v[24:27], v[12:15], 0
    v_mfma_f32_16x16x32_bf16 v[60:63], v[28:31], v[12:15], 0
    s_add_i32 s27, s23, -128
    v_add_u32 v7, s27, v2
    v_max_i32 v7, 0, v7
    v_mul_lo_u32 v7, v7, s24
    v_lshl_add_u32 v7, v3, 4, v7
    s_add_u32 s28, s26, 2048
    buffer_load_dwordx4 v[16:19], v7, s[4:7], s28 offen
    s_add_i32 s27, s23, -112
    v_add_u32 v7, s27, v2
    v_max_i32 v7, 0, v7
    v_mul_lo_u32 v7, v7, s24
    v_lshl_add_u32 v7, v3, 4, v7
    s_add_u32 s28, s26, 2048
    buffer_load_dwordx4 v[20:23], v7, s[4:7], s28 offen
    s_add_i32 s27, s23, -96
    v_add_u32 v7, s27, v2
    v_max_i32 v7, 0, v7
    v_mul_lo_u32 v7, v7, s24
    v_lshl_add_u32 v7, v3, 4, v7
    s_add_u32 s28, s26, 2048
    buffer_load_dwordx4 v[24:27], v7, s[4:7], s28 offen
    s_add_i32 s27, s23, -80
    v_add_u32 v7, s27, v2
    v_max_i32 v7, 0, v7
    v_mul_lo_u32 v7, v7, s24
    v_lshl_add_u32 v7, v3, 4, v7
    s_add_u32 s28, s26, 2048
    buffer_load_dwordx4 v[28:31], v7, s[4:7], s28 offen
    s_waitcnt vmcnt(0)
    v_mfma_f32_16x16x32_bf16 v[64:67], v[16:19], v[12:15], 0
    v_mfma_f32_16x16x32_bf16 v[68:71], v[20:23], v[12:15], 0
    v_mfma_f32_16x16x32_bf16 v[72:75], v[24:27], v[12:15], 0
    v_mfma_f32_16x16x32_bf16 v[76:79], v[28:31], v[12:15], 0
    s_add_i32 s27, s23, -64
    v_add_u32 v7, s27, v2
    v_max_i32 v7, 0, v7
    v_mul_lo_u32 v7, v7, s24
    v_lshl_add_u32 v7, v3, 4, v7
    s_add_u32 s28, s26, 2048
    buffer_load_dwordx4 v[16:19], v7, s[4:7], s28 offen
    s_add_i32 s27, s23, -48
    v_add_u32 v7, s27, v2
    v_max_i32 v7, 0, v7
    v_mul_lo_u32 v7, v7, s24
    v_lshl_add_u32 v7, v3, 4, v7
    s_add_u32 s28, s26, 2048
    buffer_load_dwordx4 v[20:23], v7, s[4:7], s28 offen
    s_add_i32 s27, s23, -32
    v_add_u32 v7, s27, v2
    v_max_i32 v7, 0, v7
    v_mul_lo_u32 v7, v7, s24
    v_lshl_add_u32 v7, v3, 4, v7
    s_add_u32 s28, s26, 2048
    buffer_load_dwordx4 v[24:27], v7, s[4:7], s28 offen
    s_add_i32 s27, s23, -16
    v_add_u32 v7, s27, v2
    v_max_i32 v7, 0, v7
    v_mul_lo_u32 v7, v7, s24
    v_lshl_add_u32 v7, v3, 4, v7
    s_add_u32 s28, s26, 2048
    buffer_load_dwordx4 v[28:31], v7, s[4:7], s28 offen
    s_waitcnt vmcnt(0)
    v_mfma_f32_16x16x32_bf16 v[80:83], v[16:19], v[12:15], 0
    v_mfma_f32_16x16x32_bf16 v[84:87], v[20:23], v[12:15], 0
    v_mfma_f32_16x16x32_bf16 v[88:91], v[24:27], v[12:15], 0
    v_mfma_f32_16x16x32_bf16 v[92:95], v[28:31], v[12:15], 0
    s_add_i32 s27, s23, 0
    v_add_u32 v7, s27, v2
    v_max_i32 v7, 0, v7
    v_mul_lo_u32 v7, v7, s24
    v_lshl_add_u32 v7, v3, 4, v7
    s_add_u32 s28, s26, 2048
    buffer_load_dwordx4 v[16:19], v7, s[4:7], s28 offen
    s_waitcnt vmcnt(0)
    v_mfma_f32_16x16x32_bf16 v[96:99], v[16:19], v[12:15], 0
    s_nop 7
    s_nop 3
    s_mov_b32 s24, 0x3e3504f3
    v_cvt_pk_bf16_f32 v32, v32, v32
    v_lshlrev_b32 v32, 16, v32
    v_mul_f32 v32, s24, v32
    v_cvt_pk_bf16_f32 v32, v32, v32
    v_lshlrev_b32 v32, 16, v32
    v_cvt_pk_bf16_f32 v33, v33, v33
    v_lshlrev_b32 v33, 16, v33
    v_mul_f32 v33, s24, v33
    v_cvt_pk_bf16_f32 v33, v33, v33
    v_lshlrev_b32 v33, 16, v33
    v_cvt_pk_bf16_f32 v34, v34, v34
    v_lshlrev_b32 v34, 16, v34
    v_mul_f32 v34, s24, v34
    v_cvt_pk_bf16_f32 v34, v34, v34
    v_lshlrev_b32 v34, 16, v34
    v_cvt_pk_bf16_f32 v35, v35, v35
    v_lshlrev_b32 v35, 16, v35
    v_mul_f32 v35, s24, v35
    v_cvt_pk_bf16_f32 v35, v35, v35
    v_lshlrev_b32 v35, 16, v35
    v_cvt_pk_bf16_f32 v36, v36, v36
    v_lshlrev_b32 v36, 16, v36
    v_mul_f32 v36, s24, v36
    v_cvt_pk_bf16_f32 v36, v36, v36
    v_lshlrev_b32 v36, 16, v36
    v_cvt_pk_bf16_f32 v37, v37, v37
    v_lshlrev_b32 v37, 16, v37
    v_mul_f32 v37, s24, v37
    v_cvt_pk_bf16_f32 v37, v37, v37
    v_lshlrev_b32 v37, 16, v37
    v_cvt_pk_bf16_f32 v38, v38, v38
    v_lshlrev_b32 v38, 16, v38
    v_mul_f32 v38, s24, v38
    v_cvt_pk_bf16_f32 v38, v38, v38
    v_lshlrev_b32 v38, 16, v38
    v_cvt_pk_bf16_f32 v39, v39, v39
    v_lshlrev_b32 v39, 16, v39
    v_mul_f32 v39, s24, v39
    v_cvt_pk_bf16_f32 v39, v39, v39
    v_lshlrev_b32 v39, 16, v39
    v_cvt_pk_bf16_f32 v40, v40, v40
    v_lshlrev_b32 v40, 16, v40
    v_mul_f32 v40, s24, v40
    v_cvt_pk_bf16_f32 v40, v40, v40
    v_lshlrev_b32 v40, 16, v40
    v_cvt_pk_bf16_f32 v41, v41, v41
    v_lshlrev_b32 v41, 16, v41
    v_mul_f32 v41, s24, v41
    v_cvt_pk_bf16_f32 v41, v41, v41
    v_lshlrev_b32 v41, 16, v41
    v_cvt_pk_bf16_f32 v42, v42, v42
    v_lshlrev_b32 v42, 16, v42
    v_mul_f32 v42, s24, v42
    v_cvt_pk_bf16_f32 v42, v42, v42
    v_lshlrev_b32 v42, 16, v42
    v_cvt_pk_bf16_f32 v43, v43, v43
    v_lshlrev_b32 v43, 16, v43
    v_mul_f32 v43, s24, v43
    v_cvt_pk_bf16_f32 v43, v43, v43
    v_lshlrev_b32 v43, 16, v43
    v_cvt_pk_bf16_f32 v44, v44, v44
    v_lshlrev_b32 v44, 16, v44
    v_mul_f32 v44, s24, v44
    v_cvt_pk_bf16_f32 v44, v44, v44
    v_lshlrev_b32 v44, 16, v44
    v_cvt_pk_bf16_f32 v45, v45, v45
    v_lshlrev_b32 v45, 16, v45
    v_mul_f32 v45, s24, v45
    v_cvt_pk_bf16_f32 v45, v45, v45
    v_lshlrev_b32 v45, 16, v45
    v_cvt_pk_bf16_f32 v46, v46, v46
    v_lshlrev_b32 v46, 16, v46
    v_mul_f32 v46, s24, v46
    v_cvt_pk_bf16_f32 v46, v46, v46
    v_lshlrev_b32 v46, 16, v46
    v_cvt_pk_bf16_f32 v47, v47, v47
    v_lshlrev_b32 v47, 16, v47
    v_mul_f32 v47, s24, v47
    v_cvt_pk_bf16_f32 v47, v47, v47
    v_lshlrev_b32 v47, 16, v47
    v_cvt_pk_bf16_f32 v48, v48, v48
    v_lshlrev_b32 v48, 16, v48
    v_mul_f32 v48, s24, v48
    v_cvt_pk_bf16_f32 v48, v48, v48
    v_lshlrev_b32 v48, 16, v48
    v_cvt_pk_bf16_f32 v49, v49, v49
    v_lshlrev_b32 v49, 16, v49
    v_mul_f32 v49, s24, v49
    v_cvt_pk_bf16_f32 v49, v49, v49
    v_lshlrev_b32 v49, 16, v49
    v_cvt_pk_bf16_f32 v50, v50, v50
    v_lshlrev_b32 v50, 16, v50
    v_mul_f32 v50, s24, v50
    v_cvt_pk_bf16_f32 v50, v50, v50
    v_lshlrev_b32 v50, 16, v50
    v_cvt_pk_bf16_f32 v51, v51, v51
    v_lshlrev_b32 v51, 16, v51
    v_mul_f32 v51, s24, v51
    v_cvt_pk_bf16_f32 v51, v51, v51
    v_lshlrev_b32 v51, 16, v51
    v_cvt_pk_bf16_f32 v52, v52, v52
    v_lshlrev_b32 v52, 16, v52
    v_mul_f32 v52, s24, v52
    v_cvt_pk_bf16_f32 v52, v52, v52
    v_lshlrev_b32 v52, 16, v52
    v_cvt_pk_bf16_f32 v53, v53, v53
    v_lshlrev_b32 v53, 16, v53
    v_mul_f32 v53, s24, v53
    v_cvt_pk_bf16_f32 v53, v53, v53
    v_lshlrev_b32 v53, 16, v53
    v_cvt_pk_bf16_f32 v54, v54, v54
    v_lshlrev_b32 v54, 16, v54
    v_mul_f32 v54, s24, v54
    v_cvt_pk_bf16_f32 v54, v54, v54
    v_lshlrev_b32 v54, 16, v54
    v_cvt_pk_bf16_f32 v55, v55, v55
    v_lshlrev_b32 v55, 16, v55
    v_mul_f32 v55, s24, v55
    v_cvt_pk_bf16_f32 v55, v55, v55
    v_lshlrev_b32 v55, 16, v55
    v_cvt_pk_bf16_f32 v56, v56, v56
    v_lshlrev_b32 v56, 16, v56
    v_mul_f32 v56, s24, v56
    v_cvt_pk_bf16_f32 v56, v56, v56
    v_lshlrev_b32 v56, 16, v56
    v_cvt_pk_bf16_f32 v57, v57, v57
    v_lshlrev_b32 v57, 16, v57
    v_mul_f32 v57, s24, v57
    v_cvt_pk_bf16_f32 v57, v57, v57
    v_lshlrev_b32 v57, 16, v57
    v_cvt_pk_bf16_f32 v58, v58, v58
    v_lshlrev_b32 v58, 16, v58
    v_mul_f32 v58, s24, v58
    v_cvt_pk_bf16_f32 v58, v58, v58
    v_lshlrev_b32 v58, 16, v58
    v_cvt_pk_bf16_f32 v59, v59, v59
    v_lshlrev_b32 v59, 16, v59
    v_mul_f32 v59, s24, v59
    v_cvt_pk_bf16_f32 v59, v59, v59
    v_lshlrev_b32 v59, 16, v59
    v_cvt_pk_bf16_f32 v60, v60, v60
    v_lshlrev_b32 v60, 16, v60
    v_mul_f32 v60, s24, v60
    v_cvt_pk_bf16_f32 v60, v60, v60
    v_lshlrev_b32 v60, 16, v60
    v_cvt_pk_bf16_f32 v61, v61, v61
    v_lshlrev_b32 v61, 16, v61
    v_mul_f32 v61, s24, v61
    v_cvt_pk_bf16_f32 v61, v61, v61
    v_lshlrev_b32 v61, 16, v61
    v_cvt_pk_bf16_f32 v62, v62, v62
    v_lshlrev_b32 v62, 16, v62
    v_mul_f32 v62, s24, v62
    v_cvt_pk_bf16_f32 v62, v62, v62
    v_lshlrev_b32 v62, 16, v62
    v_cvt_pk_bf16_f32 v63, v63, v63
    v_lshlrev_b32 v63, 16, v63
    v_mul_f32 v63, s24, v63
    v_cvt_pk_bf16_f32 v63, v63, v63
    v_lshlrev_b32 v63, 16, v63
    v_cvt_pk_bf16_f32 v64, v64, v64
    v_lshlrev_b32 v64, 16, v64
    v_mul_f32 v64, s24, v64
    v_cvt_pk_bf16_f32 v64, v64, v64
    v_lshlrev_b32 v64, 16, v64
    v_cvt_pk_bf16_f32 v65, v65, v65
    v_lshlrev_b32 v65, 16, v65
    v_mul_f32 v65, s24, v65
    v_cvt_pk_bf16_f32 v65, v65, v65
    v_lshlrev_b32 v65, 16, v65
    v_cvt_pk_bf16_f32 v66, v66, v66
    v_lshlrev_b32 v66, 16, v66
    v_mul_f32 v66, s24, v66
    v_cvt_pk_bf16_f32 v66, v66, v66
    v_lshlrev_b32 v66, 16, v66
    v_cvt_pk_bf16_f32 v67, v67, v67
    v_lshlrev_b32 v67, 16, v67
    v_mul_f32 v67, s24, v67
    v_cvt_pk_bf16_f32 v67, v67, v67
    v_lshlrev_b32 v67, 16, v67
    v_cvt_pk_bf16_f32 v68, v68, v68
    v_lshlrev_b32 v68, 16, v68
    v_mul_f32 v68, s24, v68
    v_cvt_pk_bf16_f32 v68, v68, v68
    v_lshlrev_b32 v68, 16, v68
    v_cvt_pk_bf16_f32 v69, v69, v69
    v_lshlrev_b32 v69, 16, v69
    v_mul_f32 v69, s24, v69
    v_cvt_pk_bf16_f32 v69, v69, v69
    v_lshlrev_b32 v69, 16, v69
    v_cvt_pk_bf16_f32 v70, v70, v70
    v_lshlrev_b32 v70, 16, v70
    v_mul_f32 v70, s24, v70
    v_cvt_pk_bf16_f32 v70, v70, v70
    v_lshlrev_b32 v70, 16, v70
    v_cvt_pk_bf16_f32 v71, v71, v71
    v_lshlrev_b32 v71, 16, v71
    v_mul_f32 v71, s24, v71
    v_cvt_pk_bf16_f32 v71, v71, v71
    v_lshlrev_b32 v71, 16, v71
    v_cvt_pk_bf16_f32 v72, v72, v72
    v_lshlrev_b32 v72, 16, v72
    v_mul_f32 v72, s24, v72
    v_cvt_pk_bf16_f32 v72, v72, v72
    v_lshlrev_b32 v72, 16, v72
    v_cvt_pk_bf16_f32 v73, v73, v73
    v_lshlrev_b32 v73, 16, v73
    v_mul_f32 v73, s24, v73
    v_cvt_pk_bf16_f32 v73, v73, v73
    v_lshlrev_b32 v73, 16, v73
    v_cvt_pk_bf16_f32 v74, v74, v74
    v_lshlrev_b32 v74, 16, v74
    v_mul_f32 v74, s24, v74
    v_cvt_pk_bf16_f32 v74, v74, v74
    v_lshlrev_b32 v74, 16, v74
    v_cvt_pk_bf16_f32 v75, v75, v75
    v_lshlrev_b32 v75, 16, v75
    v_mul_f32 v75, s24, v75
    v_cvt_pk_bf16_f32 v75, v75, v75
    v_lshlrev_b32 v75, 16, v75
    v_cvt_pk_bf16_f32 v76, v76, v76
    v_lshlrev_b32 v76, 16, v76
    v_mul_f32 v76, s24, v76
    v_cvt_pk_bf16_f32 v76, v76, v76
    v_lshlrev_b32 v76, 16, v76
    v_cvt_pk_bf16_f32 v77, v77, v77
    v_lshlrev_b32 v77, 16, v77
    v_mul_f32 v77, s24, v77
    v_cvt_pk_bf16_f32 v77, v77, v77
    v_lshlrev_b32 v77, 16, v77
    v_cvt_pk_bf16_f32 v78, v78, v78
    v_lshlrev_b32 v78, 16, v78
    v_mul_f32 v78, s24, v78
    v_cvt_pk_bf16_f32 v78, v78, v78
    v_lshlrev_b32 v78, 16, v78
    v_cvt_pk_bf16_f32 v79, v79, v79
    v_lshlrev_b32 v79, 16, v79
    v_mul_f32 v79, s24, v79
    v_cvt_pk_bf16_f32 v79, v79, v79
    v_lshlrev_b32 v79, 16, v79
    v_cvt_pk_bf16_f32 v80, v80, v80
    v_lshlrev_b32 v80, 16, v80
    v_mul_f32 v80, s24, v80
    v_cvt_pk_bf16_f32 v80, v80, v80
    v_lshlrev_b32 v80, 16, v80
    v_cvt_pk_bf16_f32 v81, v81, v81
    v_lshlrev_b32 v81, 16, v81
    v_mul_f32 v81, s24, v81
    v_cvt_pk_bf16_f32 v81, v81, v81
    v_lshlrev_b32 v81, 16, v81
    v_cvt_pk_bf16_f32 v82, v82, v82
    v_lshlrev_b32 v82, 16, v82
    v_mul_f32 v82, s24, v82
    v_cvt_pk_bf16_f32 v82, v82, v82
    v_lshlrev_b32 v82, 16, v82
    v_cvt_pk_bf16_f32 v83, v83, v83
    v_lshlrev_b32 v83, 16, v83
    v_mul_f32 v83, s24, v83
    v_cvt_pk_bf16_f32 v83, v83, v83
    v_lshlrev_b32 v83, 16, v83
    v_cvt_pk_bf16_f32 v84, v84, v84
    v_lshlrev_b32 v84, 16, v84
    v_mul_f32 v84, s24, v84
    v_cvt_pk_bf16_f32 v84, v84, v84
    v_lshlrev_b32 v84, 16, v84
    v_cvt_pk_bf16_f32 v85, v85, v85
    v_lshlrev_b32 v85, 16, v85
    v_mul_f32 v85, s24, v85
    v_cvt_pk_bf16_f32 v85, v85, v85
    v_lshlrev_b32 v85, 16, v85
    v_cvt_pk_bf16_f32 v86, v86, v86
    v_lshlrev_b32 v86, 16, v86
    v_mul_f32 v86, s24, v86
    v_cvt_pk_bf16_f32 v86, v86, v86
    v_lshlrev_b32 v86, 16, v86
    v_cvt_pk_bf16_f32 v87, v87, v87
    v_lshlrev_b32 v87, 16, v87
    v_mul_f32 v87, s24, v87
    v_cvt_pk_bf16_f32 v87, v87, v87
    v_lshlrev_b32 v87, 16, v87
    v_cvt_pk_bf16_f32 v88, v88, v88
    v_lshlrev_b32 v88, 16, v88
    v_mul_f32 v88, s24, v88
    v_cvt_pk_bf16_f32 v88, v88, v88
    v_lshlrev_b32 v88, 16, v88
    v_cvt_pk_bf16_f32 v89, v89, v89
    v_lshlrev_b32 v89, 16, v89
    v_mul_f32 v89, s24, v89
    v_cvt_pk_bf16_f32 v89, v89, v89
    v_lshlrev_b32 v89, 16, v89
    v_cvt_pk_bf16_f32 v90, v90, v90
    v_lshlrev_b32 v90, 16, v90
    v_mul_f32 v90, s24, v90
    v_cvt_pk_bf16_f32 v90, v90, v90
    v_lshlrev_b32 v90, 16, v90
    v_cvt_pk_bf16_f32 v91, v91, v91
    v_lshlrev_b32 v91, 16, v91
    v_mul_f32 v91, s24, v91
    v_cvt_pk_bf16_f32 v91, v91, v91
    v_lshlrev_b32 v91, 16, v91
    v_cvt_pk_bf16_f32 v92, v92, v92
    v_lshlrev_b32 v92, 16, v92
    v_mul_f32 v92, s24, v92
    v_cvt_pk_bf16_f32 v92, v92, v92
    v_lshlrev_b32 v92, 16, v92
    v_cvt_pk_bf16_f32 v93, v93, v93
    v_lshlrev_b32 v93, 16, v93
    v_mul_f32 v93, s24, v93
    v_cvt_pk_bf16_f32 v93, v93, v93
    v_lshlrev_b32 v93, 16, v93
    v_cvt_pk_bf16_f32 v94, v94, v94
    v_lshlrev_b32 v94, 16, v94
    v_mul_f32 v94, s24, v94
    v_cvt_pk_bf16_f32 v94, v94, v94
    v_lshlrev_b32 v94, 16, v94
    v_cvt_pk_bf16_f32 v95, v95, v95
    v_lshlrev_b32 v95, 16, v95
    v_mul_f32 v95, s24, v95
    v_cvt_pk_bf16_f32 v95, v95, v95
    v_lshlrev_b32 v95, 16, v95
    v_cvt_pk_bf16_f32 v96, v96, v96
    v_lshlrev_b32 v96, 16, v96
    v_mul_f32 v96, s24, v96
    v_cvt_pk_bf16_f32 v96, v96, v96
    v_lshlrev_b32 v96, 16, v96
    v_cvt_pk_bf16_f32 v97, v97, v97
    v_lshlrev_b32 v97, 16, v97
    v_mul_f32 v97, s24, v97
    v_cvt_pk_bf16_f32 v97, v97, v97
    v_lshlrev_b32 v97, 16, v97
    v_cvt_pk_bf16_f32 v98, v98, v98
    v_lshlrev_b32 v98, 16, v98
    v_mul_f32 v98, s24, v98
    v_cvt_pk_bf16_f32 v98, v98, v98
    v_lshlrev_b32 v98, 16, v98
    v_cvt_pk_bf16_f32 v99, v99, v99
    v_lshlrev_b32 v99, 16, v99
    v_mul_f32 v99, s24, v99
    v_cvt_pk_bf16_f32 v99, v99, v99
    v_lshlrev_b32 v99, 16, v99
    s_mov_b32 s24, 0xf149f2ca
    v_lshlrev_b32 v8, 2, v3
    v_sub_u32 v8, v2, v8
    v_mov_b32 v6, s24
    v_add_u32 v4, 256, v8
    v_cmp_lt_u32 vcc, 255, v4
    v_cndmask_b32 v32, v32, v6, vcc
    s_add_i32 s27, s23, -256
    v_lshl_add_u32 v7, v3, 2, s27
    v_cmp_gt_i32 vcc, 0, v7
    v_cndmask_b32 v32, v32, v6, vcc
    v_add_u32 v4, 255, v8
    v_cmp_lt_u32 vcc, 255, v4
    v_cndmask_b32 v33, v33, v6, vcc
    s_add_i32 s27, s23, -255
    v_lshl_add_u32 v7, v3, 2, s27
    v_cmp_gt_i32 vcc, 0, v7
    v_cndmask_b32 v33, v33, v6, vcc
    v_add_u32 v4, 254, v8
    v_cmp_lt_u32 vcc, 255, v4
    v_cndmask_b32 v34, v34, v6, vcc
    s_add_i32 s27, s23, -254
    v_lshl_add_u32 v7, v3, 2, s27
    v_cmp_gt_i32 vcc, 0, v7
    v_cndmask_b32 v34, v34, v6, vcc
    v_add_u32 v4, 253, v8
    v_cmp_lt_u32 vcc, 255, v4
    v_cndmask_b32 v35, v35, v6, vcc
    s_add_i32 s27, s23, -253
    v_lshl_add_u32 v7, v3, 2, s27
    v_cmp_gt_i32 vcc, 0, v7
    v_cndmask_b32 v35, v35, v6, vcc
    v_add_u32 v4, 240, v8
    v_cmp_lt_u32 vcc, 255, v4
    v_cndmask_b32 v36, v36, v6, vcc
    s_add_i32 s27, s23, -240
    v_lshl_add_u32 v7, v3, 2, s27
    v_cmp_gt_i32 vcc, 0, v7
    v_cndmask_b32 v36, v36, v6, vcc
    v_add_u32 v4, 239, v8
    v_cmp_lt_u32 vcc, 255, v4
    v_cndmask_b32 v37, v37, v6, vcc
    s_add_i32 s27, s23, -239
    v_lshl_add_u32 v7, v3, 2, s27
    v_cmp_gt_i32 vcc, 0, v7
    v_cndmask_b32 v37, v37, v6, vcc
    v_add_u32 v4, 238, v8
    v_cmp_lt_u32 vcc, 255, v4
    v_cndmask_b32 v38, v38, v6, vcc
    s_add_i32 s27, s23, -238
    v_lshl_add_u32 v7, v3, 2, s27
    v_cmp_gt_i32 vcc, 0, v7
    v_cndmask_b32 v38, v38, v6, vcc
    v_add_u32 v4, 237, v8
    v_cmp_lt_u32 vcc, 255, v4
    v_cndmask_b32 v39, v39, v6, vcc
    s_add_i32 s27, s23, -237
    v_lshl_add_u32 v7, v3, 2, s27
    v_cmp_gt_i32 vcc, 0, v7
    v_cndmask_b32 v39, v39, v6, vcc
    v_add_u32 v4, 224, v8
    v_cmp_lt_u32 vcc, 255, v4
    v_cndmask_b32 v40, v40, v6, vcc
    s_add_i32 s27, s23, -224
    v_lshl_add_u32 v7, v3, 2, s27
    v_cmp_gt_i32 vcc, 0, v7
    v_cndmask_b32 v40, v40, v6, vcc
    v_add_u32 v4, 223, v8
    v_cmp_lt_u32 vcc, 255, v4
    v_cndmask_b32 v41, v41, v6, vcc
    s_add_i32 s27, s23, -223
    v_lshl_add_u32 v7, v3, 2, s27
    v_cmp_gt_i32 vcc, 0, v7
    v_cndmask_b32 v41, v41, v6, vcc
    v_add_u32 v4, 222, v8
    v_cmp_lt_u32 vcc, 255, v4
    v_cndmask_b32 v42, v42, v6, vcc
    s_add_i32 s27, s23, -222
    v_lshl_add_u32 v7, v3, 2, s27
    v_cmp_gt_i32 vcc, 0, v7
    v_cndmask_b32 v42, v42, v6, vcc
    v_add_u32 v4, 221, v8
    v_cmp_lt_u32 vcc, 255, v4
    v_cndmask_b32 v43, v43, v6, vcc
    s_add_i32 s27, s23, -221
    v_lshl_add_u32 v7, v3, 2, s27
    v_cmp_gt_i32 vcc, 0, v7
    v_cndmask_b32 v43, v43, v6, vcc
    v_add_u32 v4, 208, v8
    v_cmp_lt_u32 vcc, 255, v4
    v_cndmask_b32 v44, v44, v6, vcc
    s_add_i32 s27, s23, -208
    v_lshl_add_u32 v7, v3, 2, s27
    v_cmp_gt_i32 vcc, 0, v7
    v_cndmask_b32 v44, v44, v6, vcc
    v_add_u32 v4, 207, v8
    v_cmp_lt_u32 vcc, 255, v4
    v_cndmask_b32 v45, v45, v6, vcc
    s_add_i32 s27, s23, -207
    v_lshl_add_u32 v7, v3, 2, s27
    v_cmp_gt_i32 vcc, 0, v7
    v_cndmask_b32 v45, v45, v6, vcc
    v_add_u32 v4, 206, v8
    v_cmp_lt_u32 vcc, 255, v4
    v_cndmask_b32 v46, v46, v6, vcc
    s_add_i32 s27, s23, -206
    v_lshl_add_u32 v7, v3, 2, s27
    v_cmp_gt_i32 vcc, 0, v7
    v_cndmask_b32 v46, v46, v6, vcc
    v_add_u32 v4, 205, v8
    v_cmp_lt_u32 vcc, 255, v4
    v_cndmask_b32 v47, v47, v6, vcc
    s_add_i32 s27, s23, -205
    v_lshl_add_u32 v7, v3, 2, s27
    v_cmp_gt_i32 vcc, 0, v7
    v_cndmask_b32 v47, v47, v6, vcc
    v_add_u32 v4, 192, v8
    v_cmp_lt_u32 vcc, 255, v4
    v_cndmask_b32 v48, v48, v6, vcc
    s_add_i32 s27, s23, -192
    v_lshl_add_u32 v7, v3, 2, s27
    v_cmp_gt_i32 vcc, 0, v7
    v_cndmask_b32 v48, v48, v6, vcc
    v_add_u32 v4, 191, v8
    v_cmp_lt_u32 vcc, 255, v4
    v_cndmask_b32 v49, v49, v6, vcc
    s_add_i32 s27, s23, -191
    v_lshl_add_u32 v7, v3, 2, s27
    v_cmp_gt_i32 vcc, 0, v7
    v_cndmask_b32 v49, v49, v6, vcc
    v_add_u32 v4, 190, v8
    v_cmp_lt_u32 vcc, 255, v4
    v_cndmask_b32 v50, v50, v6, vcc
    s_add_i32 s27, s23, -190
    v_lshl_add_u32 v7, v3, 2, s27
    v_cmp_gt_i32 vcc, 0, v7
    v_cndmask_b32 v50, v50, v6, vcc
    v_add_u32 v4, 189, v8
    v_cmp_lt_u32 vcc, 255, v4
    v_cndmask_b32 v51, v51, v6, vcc
    s_add_i32 s27, s23, -189
    v_lshl_add_u32 v7, v3, 2, s27
    v_cmp_gt_i32 vcc, 0, v7
    v_cndmask_b32 v51, v51, v6, vcc
    v_add_u32 v4, 176, v8
    v_cmp_lt_u32 vcc, 255, v4
    v_cndmask_b32 v52, v52, v6, vcc
    s_add_i32 s27, s23, -176
    v_lshl_add_u32 v7, v3, 2, s27
    v_cmp_gt_i32 vcc, 0, v7
    v_cndmask_b32 v52, v52, v6, vcc
    v_add_u32 v4, 175, v8
    v_cmp_lt_u32 vcc, 255, v4
    v_cndmask_b32 v53, v53, v6, vcc
    s_add_i32 s27, s23, -175
    v_lshl_add_u32 v7, v3, 2, s27
    v_cmp_gt_i32 vcc, 0, v7
    v_cndmask_b32 v53, v53, v6, vcc
    v_add_u32 v4, 174, v8
    v_cmp_lt_u32 vcc, 255, v4
    v_cndmask_b32 v54, v54, v6, vcc
    s_add_i32 s27, s23, -174
    v_lshl_add_u32 v7, v3, 2, s27
    v_cmp_gt_i32 vcc, 0, v7
    v_cndmask_b32 v54, v54, v6, vcc
    v_add_u32 v4, 173, v8
    v_cmp_lt_u32 vcc, 255, v4
    v_cndmask_b32 v55, v55, v6, vcc
    s_add_i32 s27, s23, -173
    v_lshl_add_u32 v7, v3, 2, s27
    v_cmp_gt_i32 vcc, 0, v7
    v_cndmask_b32 v55, v55, v6, vcc
    v_add_u32 v4, 160, v8
    v_cmp_lt_u32 vcc, 255, v4
    v_cndmask_b32 v56, v56, v6, vcc
    s_add_i32 s27, s23, -160
    v_lshl_add_u32 v7, v3, 2, s27
    v_cmp_gt_i32 vcc, 0, v7
    v_cndmask_b32 v56, v56, v6, vcc
    v_add_u32 v4, 159, v8
    v_cmp_lt_u32 vcc, 255, v4
    v_cndmask_b32 v57, v57, v6, vcc
    s_add_i32 s27, s23, -159
    v_lshl_add_u32 v7, v3, 2, s27
    v_cmp_gt_i32 vcc, 0, v7
    v_cndmask_b32 v57, v57, v6, vcc
    v_add_u32 v4, 158, v8
    v_cmp_lt_u32 vcc, 255, v4
    v_cndmask_b32 v58, v58, v6, vcc
    s_add_i32 s27, s23, -158
    v_lshl_add_u32 v7, v3, 2, s27
    v_cmp_gt_i32 vcc, 0, v7
    v_cndmask_b32 v58, v58, v6, vcc
    v_add_u32 v4, 157, v8
    v_cmp_lt_u32 vcc, 255, v4
    v_cndmask_b32 v59, v59, v6, vcc
    s_add_i32 s27, s23, -157
    v_lshl_add_u32 v7, v3, 2, s27
    v_cmp_gt_i32 vcc, 0, v7
    v_cndmask_b32 v59, v59, v6, vcc
    v_add_u32 v4, 144, v8
    v_cmp_lt_u32 vcc, 255, v4
    v_cndmask_b32 v60, v60, v6, vcc
    s_add_i32 s27, s23, -144
    v_lshl_add_u32 v7, v3, 2, s27
    v_cmp_gt_i32 vcc, 0, v7
    v_cndmask_b32 v60, v60, v6, vcc
    v_add_u32 v4, 143, v8
    v_cmp_lt_u32 vcc, 255, v4
    v_cndmask_b32 v61, v61, v6, vcc
    s_add_i32 s27, s23, -143
    v_lshl_add_u32 v7, v3, 2, s27
    v_cmp_gt_i32 vcc, 0, v7
    v_cndmask_b32 v61, v61, v6, vcc
    v_add_u32 v4, 142, v8
    v_cmp_lt_u32 vcc, 255, v4
    v_cndmask_b32 v62, v62, v6, vcc
    s_add_i32 s27, s23, -142
    v_lshl_add_u32 v7, v3, 2, s27
    v_cmp_gt_i32 vcc, 0, v7
    v_cndmask_b32 v62, v62, v6, vcc
    v_add_u32 v4, 141, v8
    v_cmp_lt_u32 vcc, 255, v4
    v_cndmask_b32 v63, v63, v6, vcc
    s_add_i32 s27, s23, -141
    v_lshl_add_u32 v7, v3, 2, s27
    v_cmp_gt_i32 vcc, 0, v7
    v_cndmask_b32 v63, v63, v6, vcc
    v_add_u32 v4, 128, v8
    v_cmp_lt_u32 vcc, 255, v4
    v_cndmask_b32 v64, v64, v6, vcc
    s_add_i32 s27, s23, -128
    v_lshl_add_u32 v7, v3, 2, s27
    v_cmp_gt_i32 vcc, 0, v7
    v_cndmask_b32 v64, v64, v6, vcc
    v_add_u32 v4, 127, v8
    v_cmp_lt_u32 vcc, 255, v4
    v_cndmask_b32 v65, v65, v6, vcc
    s_add_i32 s27, s23, -127
    v_lshl_add_u32 v7, v3, 2, s27
    v_cmp_gt_i32 vcc, 0, v7
    v_cndmask_b32 v65, v65, v6, vcc
    v_add_u32 v4, 126, v8
    v_cmp_lt_u32 vcc, 255, v4
    v_cndmask_b32 v66, v66, v6, vcc
    s_add_i32 s27, s23, -126
    v_lshl_add_u32 v7, v3, 2, s27
    v_cmp_gt_i32 vcc, 0, v7
    v_cndmask_b32 v66, v66, v6, vcc
    v_add_u32 v4, 125, v8
    v_cmp_lt_u32 vcc, 255, v4
    v_cndmask_b32 v67, v67, v6, vcc
    s_add_i32 s27, s23, -125
    v_lshl_add_u32 v7, v3, 2, s27
    v_cmp_gt_i32 vcc, 0, v7
    v_cndmask_b32 v67, v67, v6, vcc
    v_add_u32 v4, 112, v8
    v_cmp_lt_u32 vcc, 255, v4
    v_cndmask_b32 v68, v68, v6, vcc
    s_add_i32 s27, s23, -112
    v_lshl_add_u32 v7, v3, 2, s27
    v_cmp_gt_i32 vcc, 0, v7
    v_cndmask_b32 v68, v68, v6, vcc
    v_add_u32 v4, 111, v8
    v_cmp_lt_u32 vcc, 255, v4
    v_cndmask_b32 v69, v69, v6, vcc
    s_add_i32 s27, s23, -111
    v_lshl_add_u32 v7, v3, 2, s27
    v_cmp_gt_i32 vcc, 0, v7
    v_cndmask_b32 v69, v69, v6, vcc
    v_add_u32 v4, 110, v8
    v_cmp_lt_u32 vcc, 255, v4
    v_cndmask_b32 v70, v70, v6, vcc
    s_add_i32 s27, s23, -110
    v_lshl_add_u32 v7, v3, 2, s27
    v_cmp_gt_i32 vcc, 0, v7
    v_cndmask_b32 v70, v70, v6, vcc
    v_add_u32 v4, 109, v8
    v_cmp_lt_u32 vcc, 255, v4
    v_cndmask_b32 v71, v71, v6, vcc
    s_add_i32 s27, s23, -109
    v_lshl_add_u32 v7, v3, 2, s27
    v_cmp_gt_i32 vcc, 0, v7
    v_cndmask_b32 v71, v71, v6, vcc
    v_add_u32 v4, 96, v8
    v_cmp_lt_u32 vcc, 255, v4
    v_cndmask_b32 v72, v72, v6, vcc
    s_add_i32 s27, s23, -96
    v_lshl_add_u32 v7, v3, 2, s27
    v_cmp_gt_i32 vcc, 0, v7
    v_cndmask_b32 v72, v72, v6, vcc
    v_add_u32 v4, 95, v8
    v_cmp_lt_u32 vcc, 255, v4
    v_cndmask_b32 v73, v73, v6, vcc
    s_add_i32 s27, s23, -95
    v_lshl_add_u32 v7, v3, 2, s27
    v_cmp_gt_i32 vcc, 0, v7
    v_cndmask_b32 v73, v73, v6, vcc
    v_add_u32 v4, 94, v8
    v_cmp_lt_u32 vcc, 255, v4
    v_cndmask_b32 v74, v74, v6, vcc
    s_add_i32 s27, s23, -94
    v_lshl_add_u32 v7, v3, 2, s27
    v_cmp_gt_i32 vcc, 0, v7
    v_cndmask_b32 v74, v74, v6, vcc
    v_add_u32 v4, 93, v8
    v_cmp_lt_u32 vcc, 255, v4
    v_cndmask_b32 v75, v75, v6, vcc
    s_add_i32 s27, s23, -93
    v_lshl_add_u32 v7, v3, 2, s27
    v_cmp_gt_i32 vcc, 0, v7
    v_cndmask_b32 v75, v75, v6, vcc
    v_add_u32 v4, 80, v8
    v_cmp_lt_u32 vcc, 255, v4
    v_cndmask_b32 v76, v76, v6, vcc
    s_add_i32 s27, s23, -80
    v_lshl_add_u32 v7, v3, 2, s27
    v_cmp_gt_i32 vcc, 0, v7
    v_cndmask_b32 v76, v76, v6, vcc
    v_add_u32 v4, 79, v8
    v_cmp_lt_u32 vcc, 255, v4
    v_cndmask_b32 v77, v77, v6, vcc
    s_add_i32 s27, s23, -79
    v_lshl_add_u32 v7, v3, 2, s27
    v_cmp_gt_i32 vcc, 0, v7
    v_cndmask_b32 v77, v77, v6, vcc
    v_add_u32 v4, 78, v8
    v_cmp_lt_u32 vcc, 255, v4
    v_cndmask_b32 v78, v78, v6, vcc
    s_add_i32 s27, s23, -78
    v_lshl_add_u32 v7, v3, 2, s27
    v_cmp_gt_i32 vcc, 0, v7
    v_cndmask_b32 v78, v78, v6, vcc
    v_add_u32 v4, 77, v8
    v_cmp_lt_u32 vcc, 255, v4
    v_cndmask_b32 v79, v79, v6, vcc
    s_add_i32 s27, s23, -77
    v_lshl_add_u32 v7, v3, 2, s27
    v_cmp_gt_i32 vcc, 0, v7
    v_cndmask_b32 v79, v79, v6, vcc
    v_add_u32 v4, 64, v8
    v_cmp_lt_u32 vcc, 255, v4
    v_cndmask_b32 v80, v80, v6, vcc
    s_add_i32 s27, s23, -64
    v_lshl_add_u32 v7, v3, 2, s27
    v_cmp_gt_i32 vcc, 0, v7
    v_cndmask_b32 v80, v80, v6, vcc
    v_add_u32 v4, 63, v8
    v_cmp_lt_u32 vcc, 255, v4
    v_cndmask_b32 v81, v81, v6, vcc
    s_add_i32 s27, s23, -63
    v_lshl_add_u32 v7, v3, 2, s27
    v_cmp_gt_i32 vcc, 0, v7
    v_cndmask_b32 v81, v81, v6, vcc
    v_add_u32 v4, 62, v8
    v_cmp_lt_u32 vcc, 255, v4
    v_cndmask_b32 v82, v82, v6, vcc
    s_add_i32 s27, s23, -62
    v_lshl_add_u32 v7, v3, 2, s27
    v_cmp_gt_i32 vcc, 0, v7
    v_cndmask_b32 v82, v82, v6, vcc
    v_add_u32 v4, 61, v8
    v_cmp_lt_u32 vcc, 255, v4
    v_cndmask_b32 v83, v83, v6, vcc
    s_add_i32 s27, s23, -61
    v_lshl_add_u32 v7, v3, 2, s27
    v_cmp_gt_i32 vcc, 0, v7
    v_cndmask_b32 v83, v83, v6, vcc
    v_add_u32 v4, 48, v8
    v_cmp_lt_u32 vcc, 255, v4
    v_cndmask_b32 v84, v84, v6, vcc
    s_add_i32 s27, s23, -48
    v_lshl_add_u32 v7, v3, 2, s27
    v_cmp_gt_i32 vcc, 0, v7
    v_cndmask_b32 v84, v84, v6, vcc
    v_add_u32 v4, 47, v8
    v_cmp_lt_u32 vcc, 255, v4
    v_cndmask_b32 v85, v85, v6, vcc
    s_add_i32 s27, s23, -47
    v_lshl_add_u32 v7, v3, 2, s27
    v_cmp_gt_i32 vcc, 0, v7
    v_cndmask_b32 v85, v85, v6, vcc
    v_add_u32 v4, 46, v8
    v_cmp_lt_u32 vcc, 255, v4
    v_cndmask_b32 v86, v86, v6, vcc
    s_add_i32 s27, s23, -46
    v_lshl_add_u32 v7, v3, 2, s27
    v_cmp_gt_i32 vcc, 0, v7
    v_cndmask_b32 v86, v86, v6, vcc
    v_add_u32 v4, 45, v8
    v_cmp_lt_u32 vcc, 255, v4
    v_cndmask_b32 v87, v87, v6, vcc
    s_add_i32 s27, s23, -45
    v_lshl_add_u32 v7, v3, 2, s27
    v_cmp_gt_i32 vcc, 0, v7
    v_cndmask_b32 v87, v87, v6, vcc
    v_add_u32 v4, 32, v8
    v_cmp_lt_u32 vcc, 255, v4
    v_cndmask_b32 v88, v88, v6, vcc
    s_add_i32 s27, s23, -32
    v_lshl_add_u32 v7, v3, 2, s27
    v_cmp_gt_i32 vcc, 0, v7
    v_cndmask_b32 v88, v88, v6, vcc
    v_add_u32 v4, 31, v8
    v_cmp_lt_u32 vcc, 255, v4
    v_cndmask_b32 v89, v89, v6, vcc
    s_add_i32 s27, s23, -31
    v_lshl_add_u32 v7, v3, 2, s27
    v_cmp_gt_i32 vcc, 0, v7
    v_cndmask_b32 v89, v89, v6, vcc
    v_add_u32 v4, 30, v8
    v_cmp_lt_u32 vcc, 255, v4
    v_cndmask_b32 v90, v90, v6, vcc
    s_add_i32 s27, s23, -30
    v_lshl_add_u32 v7, v3, 2, s27
    v_cmp_gt_i32 vcc, 0, v7
    v_cndmask_b32 v90, v90, v6, vcc
    v_add_u32 v4, 29, v8
    v_cmp_lt_u32 vcc, 255, v4
    v_cndmask_b32 v91, v91, v6, vcc
    s_add_i32 s27, s23, -29
    v_lshl_add_u32 v7, v3, 2, s27
    v_cmp_gt_i32 vcc, 0, v7
    v_cndmask_b32 v91, v91, v6, vcc
    v_add_u32 v4, 16, v8
    v_cmp_lt_u32 vcc, 255, v4
    v_cndmask_b32 v92, v92, v6, vcc
    s_add_i32 s27, s23, -16
    v_lshl_add_u32 v7, v3, 2, s27
    v_cmp_gt_i32 vcc, 0, v7
    v_cndmask_b32 v92, v92, v6, vcc
    v_add_u32 v4, 15, v8
    v_cmp_lt_u32 vcc, 255, v4
    v_cndmask_b32 v93, v93, v6, vcc
    s_add_i32 s27, s23, -15
    v_lshl_add_u32 v7, v3, 2, s27
    v_cmp_gt_i32 vcc, 0, v7
    v_cndmask_b32 v93, v93, v6, vcc
    v_add_u32 v4, 14, v8
    v_cmp_lt_u32 vcc, 255, v4
    v_cndmask_b32 v94, v94, v6, vcc
    s_add_i32 s27, s23, -14
    v_lshl_add_u32 v7, v3, 2, s27
    v_cmp_gt_i32 vcc, 0, v7
    v_cndmask_b32 v94, v94, v6, vcc
    v_add_u32 v4, 13, v8
    v_cmp_lt_u32 vcc, 255, v4
    v_cndmask_b32 v95, v95, v6, vcc
    s_add_i32 s27, s23, -13
    v_lshl_add_u32 v7, v3, 2, s27
    v_cmp_gt_i32 vcc, 0, v7
    v_cndmask_b32 v95, v95, v6, vcc
    v_add_u32 v4, 0, v8
    v_cmp_lt_u32 vcc, 255, v4
    v_cndmask_b32 v96, v96, v6, vcc
    s_add_i32 s27, s23, 0
    v_lshl_add_u32 v7, v3, 2, s27
    v_cmp_gt_i32 vcc, 0, v7
    v_cndmask_b32 v96, v96, v6, vcc
    v_add_u32 v4, -1, v8
    v_cmp_lt_u32 vcc, 255, v4
    v_cndmask_b32 v97, v97, v6, vcc
    s_add_i32 s27, s23, 1
    v_lshl_add_u32 v7, v3, 2, s27
    v_cmp_gt_i32 vcc, 0, v7
    v_cndmask_b32 v97, v97, v6, vcc
    v_add_u32 v4, -2, v8
    v_cmp_lt_u32 vcc, 255, v4
    v_cndmask_b32 v98, v98, v6, vcc
    s_add_i32 s27, s23, 2
    v_lshl_add_u32 v7, v3, 2, s27
    v_cmp_gt_i32 vcc, 0, v7
    v_cndmask_b32 v98, v98, v6, vcc
    v_add_u32 v4, -3, v8
    v_cmp_lt_u32 vcc, 255, v4
    v_cndmask_b32 v99, v99, v6, vcc
    s_add_i32 s27, s23, 3
    v_lshl_add_u32 v7, v3, 2, s27
    v_cmp_gt_i32 vcc, 0, v7
    v_cndmask_b32 v99, v99, v6, vcc
    v_max3_f32 v4, v32, v33, v34
    v_max3_f32 v4, v4, v35, v36
    v_max3_f32 v4, v4, v37, v38
    v_max3_f32 v4, v4, v39, v40
    v_max3_f32 v4, v4, v41, v42
    v_max3_f32 v4, v4, v43, v44
    v_max3_f32 v4, v4, v45, v46
    v_max3_f32 v4, v4, v47, v48
    v_max3_f32 v4, v4, v49, v50
    v_max3_f32 v4, v4, v51, v52
    v_max3_f32 v4, v4, v53, v54
    v_max3_f32 v4, v4, v55, v56
    v_max3_f32 v4, v4, v57, v58
    v_max3_f32 v4, v4, v59, v60
    v_max3_f32 v4, v4, v61, v62
    v_max3_f32 v4, v4, v63, v64
    v_max3_f32 v4, v4, v65, v66
    v_max3_f32 v4, v4, v67, v68
    v_max3_f32 v4, v4, v69, v70
    v_max3_f32 v4, v4, v71, v72
    v_max3_f32 v4, v4, v73, v74
    v_max3_f32 v4, v4, v75, v76
    v_max3_f32 v4, v4, v77, v78
    v_max3_f32 v4, v4, v79, v80
    v_max3_f32 v4, v4, v81, v82
    v_max3_f32 v4, v4, v83, v84
    v_max3_f32 v4, v4, v85, v86
    v_max3_f32 v4, v4, v87, v88
    v_max3_f32 v4, v4, v89, v90
    v_max3_f32 v4, v4, v91, v92
    v_max3_f32 v4, v4, v93, v94
    v_max3_f32 v4, v4, v95, v96
    v_max3_f32 v4, v4, v97, v98
    v_max_f32 v4, v4, v99
    v_xor_b32 v6, 16, v1
    v_lshlrev_b32 v6, 2, v6
    ds_bpermute_b32 v7, v6, v4
    s_waitcnt lgkmcnt(0)
    v_max_f32 v4, v4, v7
    v_xor_b32 v6, 32, v1
    v_lshlrev_b32 v6, 2, v6
    ds_bpermute_b32 v7, v6, v4
    s_waitcnt lgkmcnt(0)
    v_max_f32 v4, v4, v7
    s_mov_b32 s24, 0x3fb8aa3b
    v_sub_f32 v32, v32, v4
    v_mul_f32 v32, s24, v32
    v_exp_f32 v32, v32
    v_sub_f32 v33, v33, v4
    v_mul_f32 v33, s24, v33
    v_exp_f32 v33, v33
    v_sub_f32 v34, v34, v4
    v_mul_f32 v34, s24, v34
    v_exp_f32 v34, v34
    v_sub_f32 v35, v35, v4
    v_mul_f32 v35, s24, v35
    v_exp_f32 v35, v35
    v_sub_f32 v36, v36, v4
    v_mul_f32 v36, s24, v36
    v_exp_f32 v36, v36
    v_sub_f32 v37, v37, v4
    v_mul_f32 v37, s24, v37
    v_exp_f32 v37, v37
    v_sub_f32 v38, v38, v4
    v_mul_f32 v38, s24, v38
    v_exp_f32 v38, v38
    v_sub_f32 v39, v39, v4
    v_mul_f32 v39, s24, v39
    v_exp_f32 v39, v39
    v_sub_f32 v40, v40, v4
    v_mul_f32 v40, s24, v40
    v_exp_f32 v40, v40
    v_sub_f32 v41, v41, v4
    v_mul_f32 v41, s24, v41
    v_exp_f32 v41, v41
    v_sub_f32 v42, v42, v4
    v_mul_f32 v42, s24, v42
    v_exp_f32 v42, v42
    v_sub_f32 v43, v43, v4
    v_mul_f32 v43, s24, v43
    v_exp_f32 v43, v43
    v_sub_f32 v44, v44, v4
    v_mul_f32 v44, s24, v44
    v_exp_f32 v44, v44
    v_sub_f32 v45, v45, v4
    v_mul_f32 v45, s24, v45
    v_exp_f32 v45, v45
    v_sub_f32 v46, v46, v4
    v_mul_f32 v46, s24, v46
    v_exp_f32 v46, v46
    v_sub_f32 v47, v47, v4
    v_mul_f32 v47, s24, v47
    v_exp_f32 v47, v47
    v_sub_f32 v48, v48, v4
    v_mul_f32 v48, s24, v48
    v_exp_f32 v48, v48
    v_sub_f32 v49, v49, v4
    v_mul_f32 v49, s24, v49
    v_exp_f32 v49, v49
    v_sub_f32 v50, v50, v4
    v_mul_f32 v50, s24, v50
    v_exp_f32 v50, v50
    v_sub_f32 v51, v51, v4
    v_mul_f32 v51, s24, v51
    v_exp_f32 v51, v51
    v_sub_f32 v52, v52, v4
    v_mul_f32 v52, s24, v52
    v_exp_f32 v52, v52
    v_sub_f32 v53, v53, v4
    v_mul_f32 v53, s24, v53
    v_exp_f32 v53, v53
    v_sub_f32 v54, v54, v4
    v_mul_f32 v54, s24, v54
    v_exp_f32 v54, v54
    v_sub_f32 v55, v55, v4
    v_mul_f32 v55, s24, v55
    v_exp_f32 v55, v55
    v_sub_f32 v56, v56, v4
    v_mul_f32 v56, s24, v56
    v_exp_f32 v56, v56
    v_sub_f32 v57, v57, v4
    v_mul_f32 v57, s24, v57
    v_exp_f32 v57, v57
    v_sub_f32 v58, v58, v4
    v_mul_f32 v58, s24, v58
    v_exp_f32 v58, v58
    v_sub_f32 v59, v59, v4
    v_mul_f32 v59, s24, v59
    v_exp_f32 v59, v59
    v_sub_f32 v60, v60, v4
    v_mul_f32 v60, s24, v60
    v_exp_f32 v60, v60
    v_sub_f32 v61, v61, v4
    v_mul_f32 v61, s24, v61
    v_exp_f32 v61, v61
    v_sub_f32 v62, v62, v4
    v_mul_f32 v62, s24, v62
    v_exp_f32 v62, v62
    v_sub_f32 v63, v63, v4
    v_mul_f32 v63, s24, v63
    v_exp_f32 v63, v63
    v_sub_f32 v64, v64, v4
    v_mul_f32 v64, s24, v64
    v_exp_f32 v64, v64
    v_sub_f32 v65, v65, v4
    v_mul_f32 v65, s24, v65
    v_exp_f32 v65, v65
    v_sub_f32 v66, v66, v4
    v_mul_f32 v66, s24, v66
    v_exp_f32 v66, v66
    v_sub_f32 v67, v67, v4
    v_mul_f32 v67, s24, v67
    v_exp_f32 v67, v67
    v_sub_f32 v68, v68, v4
    v_mul_f32 v68, s24, v68
    v_exp_f32 v68, v68
    v_sub_f32 v69, v69, v4
    v_mul_f32 v69, s24, v69
    v_exp_f32 v69, v69
    v_sub_f32 v70, v70, v4
    v_mul_f32 v70, s24, v70
    v_exp_f32 v70, v70
    v_sub_f32 v71, v71, v4
    v_mul_f32 v71, s24, v71
    v_exp_f32 v71, v71
    v_sub_f32 v72, v72, v4
    v_mul_f32 v72, s24, v72
    v_exp_f32 v72, v72
    v_sub_f32 v73, v73, v4
    v_mul_f32 v73, s24, v73
    v_exp_f32 v73, v73
    v_sub_f32 v74, v74, v4
    v_mul_f32 v74, s24, v74
    v_exp_f32 v74, v74
    v_sub_f32 v75, v75, v4
    v_mul_f32 v75, s24, v75
    v_exp_f32 v75, v75
    v_sub_f32 v76, v76, v4
    v_mul_f32 v76, s24, v76
    v_exp_f32 v76, v76
    v_sub_f32 v77, v77, v4
    v_mul_f32 v77, s24, v77
    v_exp_f32 v77, v77
    v_sub_f32 v78, v78, v4
    v_mul_f32 v78, s24, v78
    v_exp_f32 v78, v78
    v_sub_f32 v79, v79, v4
    v_mul_f32 v79, s24, v79
    v_exp_f32 v79, v79
    v_sub_f32 v80, v80, v4
    v_mul_f32 v80, s24, v80
    v_exp_f32 v80, v80
    v_sub_f32 v81, v81, v4
    v_mul_f32 v81, s24, v81
    v_exp_f32 v81, v81
    v_sub_f32 v82, v82, v4
    v_mul_f32 v82, s24, v82
    v_exp_f32 v82, v82
    v_sub_f32 v83, v83, v4
    v_mul_f32 v83, s24, v83
    v_exp_f32 v83, v83
    v_sub_f32 v84, v84, v4
    v_mul_f32 v84, s24, v84
    v_exp_f32 v84, v84
    v_sub_f32 v85, v85, v4
    v_mul_f32 v85, s24, v85
    v_exp_f32 v85, v85
    v_sub_f32 v86, v86, v4
    v_mul_f32 v86, s24, v86
    v_exp_f32 v86, v86
    v_sub_f32 v87, v87, v4
    v_mul_f32 v87, s24, v87
    v_exp_f32 v87, v87
    v_sub_f32 v88, v88, v4
    v_mul_f32 v88, s24, v88
    v_exp_f32 v88, v88
    v_sub_f32 v89, v89, v4
    v_mul_f32 v89, s24, v89
    v_exp_f32 v89, v89
    v_sub_f32 v90, v90, v4
    v_mul_f32 v90, s24, v90
    v_exp_f32 v90, v90
    v_sub_f32 v91, v91, v4
    v_mul_f32 v91, s24, v91
    v_exp_f32 v91, v91
    v_sub_f32 v92, v92, v4
    v_mul_f32 v92, s24, v92
    v_exp_f32 v92, v92
    v_sub_f32 v93, v93, v4
    v_mul_f32 v93, s24, v93
    v_exp_f32 v93, v93
    v_sub_f32 v94, v94, v4
    v_mul_f32 v94, s24, v94
    v_exp_f32 v94, v94
    v_sub_f32 v95, v95, v4
    v_mul_f32 v95, s24, v95
    v_exp_f32 v95, v95
    v_sub_f32 v96, v96, v4
    v_mul_f32 v96, s24, v96
    v_exp_f32 v96, v96
    v_sub_f32 v97, v97, v4
    v_mul_f32 v97, s24, v97
    v_exp_f32 v97, v97
    v_sub_f32 v98, v98, v4
    v_mul_f32 v98, s24, v98
    v_exp_f32 v98, v98
    v_sub_f32 v99, v99, v4
    v_mul_f32 v99, s24, v99
    v_exp_f32 v99, v99
    s_nop 0
    v_add_f32 v4, v32, v33
    v_add_f32 v4, v4, v34
    v_add_f32 v4, v4, v35
    v_add_f32 v4, v4, v36
    v_add_f32 v4, v4, v37
    v_add_f32 v4, v4, v38
    v_add_f32 v4, v4, v39
    v_add_f32 v4, v4, v40
    v_add_f32 v4, v4, v41
    v_add_f32 v4, v4, v42
    v_add_f32 v4, v4, v43
    v_add_f32 v4, v4, v44
    v_add_f32 v4, v4, v45
    v_add_f32 v4, v4, v46
    v_add_f32 v4, v4, v47
    v_add_f32 v4, v4, v48
    v_add_f32 v4, v4, v49
    v_add_f32 v4, v4, v50
    v_add_f32 v4, v4, v51
    v_add_f32 v4, v4, v52
    v_add_f32 v4, v4, v53
    v_add_f32 v4, v4, v54
    v_add_f32 v4, v4, v55
    v_add_f32 v4, v4, v56
    v_add_f32 v4, v4, v57
    v_add_f32 v4, v4, v58
    v_add_f32 v4, v4, v59
    v_add_f32 v4, v4, v60
    v_add_f32 v4, v4, v61
    v_add_f32 v4, v4, v62
    v_add_f32 v4, v4, v63
    v_add_f32 v4, v4, v64
    v_add_f32 v4, v4, v65
    v_add_f32 v4, v4, v66
    v_add_f32 v4, v4, v67
    v_add_f32 v4, v4, v68
    v_add_f32 v4, v4, v69
    v_add_f32 v4, v4, v70
    v_add_f32 v4, v4, v71
    v_add_f32 v4, v4, v72
    v_add_f32 v4, v4, v73
    v_add_f32 v4, v4, v74
    v_add_f32 v4, v4, v75
    v_add_f32 v4, v4, v76
    v_add_f32 v4, v4, v77
    v_add_f32 v4, v4, v78
    v_add_f32 v4, v4, v79
    v_add_f32 v4, v4, v80
    v_add_f32 v4, v4, v81
    v_add_f32 v4, v4, v82
    v_add_f32 v4, v4, v83
    v_add_f32 v4, v4, v84
    v_add_f32 v4, v4, v85
    v_add_f32 v4, v4, v86
    v_add_f32 v4, v4, v87
    v_add_f32 v4, v4, v88
    v_add_f32 v4, v4, v89
    v_add_f32 v4, v4, v90
    v_add_f32 v4, v4, v91
    v_add_f32 v4, v4, v92
    v_add_f32 v4, v4, v93
    v_add_f32 v4, v4, v94
    v_add_f32 v4, v4, v95
    v_add_f32 v4, v4, v96
    v_add_f32 v4, v4, v97
    v_add_f32 v4, v4, v98
    v_add_f32 v4, v4, v99
    v_xor_b32 v6, 16, v1
    v_lshlrev_b32 v6, 2, v6
    ds_bpermute_b32 v7, v6, v4
    s_waitcnt lgkmcnt(0)
    v_add_f32 v4, v4, v7
    v_xor_b32 v6, 32, v1
    v_lshlrev_b32 v6, 2, v6
    ds_bpermute_b32 v7, v6, v4
    s_waitcnt lgkmcnt(0)
    v_add_f32 v4, v4, v7
    v_rcp_f32 v4, v4
    s_nop 0
    v_mul_f32 v32, v32, v4
    v_mul_f32 v33, v33, v4
    v_mul_f32 v34, v34, v4
    v_mul_f32 v35, v35, v4
    v_mul_f32 v36, v36, v4
    v_mul_f32 v37, v37, v4
    v_mul_f32 v38, v38, v4
    v_mul_f32 v39, v39, v4
    v_mul_f32 v40, v40, v4
    v_mul_f32 v41, v41, v4
    v_mul_f32 v42, v42, v4
    v_mul_f32 v43, v43, v4
    v_mul_f32 v44, v44, v4
    v_mul_f32 v45, v45, v4
    v_mul_f32 v46, v46, v4
    v_mul_f32 v47, v47, v4
    v_mul_f32 v48, v48, v4
    v_mul_f32 v49, v49, v4
    v_mul_f32 v50, v50, v4
    v_mul_f32 v51, v51, v4
    v_mul_f32 v52, v52, v4
    v_mul_f32 v53, v53, v4
    v_mul_f32 v54, v54, v4
    v_mul_f32 v55, v55, v4
    v_mul_f32 v56, v56, v4
    v_mul_f32 v57, v57, v4
    v_mul_f32 v58, v58, v4
    v_mul_f32 v59, v59, v4
    v_mul_f32 v60, v60, v4
    v_mul_f32 v61, v61, v4
    v_mul_f32 v62, v62, v4
    v_mul_f32 v63, v63, v4
    v_mul_f32 v64, v64, v4
    v_mul_f32 v65, v65, v4
    v_mul_f32 v66, v66, v4
    v_mul_f32 v67, v67, v4
    v_mul_f32 v68, v68, v4
    v_mul_f32 v69, v69, v4
    v_mul_f32 v70, v70, v4
    v_mul_f32 v71, v71, v4
    v_mul_f32 v72, v72, v4
    v_mul_f32 v73, v73, v4
    v_mul_f32 v74, v74, v4
    v_mul_f32 v75, v75, v4
    v_mul_f32 v76, v76, v4
    v_mul_f32 v77, v77, v4
    v_mul_f32 v78, v78, v4
    v_mul_f32 v79, v79, v4
    v_mul_f32 v80, v80, v4
    v_mul_f32 v81, v81, v4
    v_mul_f32 v82, v82, v4
    v_mul_f32 v83, v83, v4
    v_mul_f32 v84, v84, v4
    v_mul_f32 v85, v85, v4
    v_mul_f32 v86, v86, v4
    v_mul_f32 v87, v87, v4
    v_mul_f32 v88, v88, v4
    v_mul_f32 v89, v89, v4
    v_mul_f32 v90, v90, v4
    v_mul_f32 v91, v91, v4
    v_mul_f32 v92, v92, v4
    v_mul_f32 v93, v93, v4
    v_mul_f32 v94, v94, v4
    v_mul_f32 v95, v95, v4
    v_mul_f32 v96, v96, v4
    v_mul_f32 v97, v97, v4
    v_mul_f32 v98, v98, v4
    v_mul_f32 v99, v99, v4
    v_cvt_pk_bf16_f32 v100, v32, v33
    v_cvt_pk_bf16_f32 v101, v34, v35
    v_cvt_pk_bf16_f32 v102, v36, v37
    v_cvt_pk_bf16_f32 v103, v38, v39
    v_cvt_pk_bf16_f32 v104, v40, v41
    v_cvt_pk_bf16_f32 v105, v42, v43
    v_cvt_pk_bf16_f32 v106, v44, v45
    v_cvt_pk_bf16_f32 v107, v46, v47
    v_cvt_pk_bf16_f32 v108, v48, v49
    v_cvt_pk_bf16_f32 v109, v50, v51
    v_cvt_pk_bf16_f32 v110, v52, v53
    v_cvt_pk_bf16_f32 v111, v54, v55
    v_cvt_pk_bf16_f32 v112, v56, v57
    v_cvt_pk_bf16_f32 v113, v58, v59
    v_cvt_pk_bf16_f32 v114, v60, v61
    v_cvt_pk_bf16_f32 v115, v62, v63
    v_cvt_pk_bf16_f32 v116, v64, v65
    v_cvt_pk_bf16_f32 v117, v66, v67
    v_cvt_pk_bf16_f32 v118, v68, v69
    v_cvt_pk_bf16_f32 v119, v70, v71
    v_cvt_pk_bf16_f32 v120, v72, v73
    v_cvt_pk_bf16_f32 v121, v74, v75
    v_cvt_pk_bf16_f32 v122, v76, v77
    v_cvt_pk_bf16_f32 v123, v78, v79
    v_cvt_pk_bf16_f32 v124, v80, v81
    v_cvt_pk_bf16_f32 v125, v82, v83
    v_cvt_pk_bf16_f32 v126, v84, v85
    v_cvt_pk_bf16_f32 v127, v86, v87
    v_cvt_pk_bf16_f32 v128, v88, v89
    v_cvt_pk_bf16_f32 v129, v90, v91
    v_cvt_pk_bf16_f32 v130, v92, v93
    v_cvt_pk_bf16_f32 v131, v94, v95
    v_cvt_pk_bf16_f32 v132, v96, v97
    v_cvt_pk_bf16_f32 v133, v98, v99
    v_mov_b32 v134, 0
    v_mov_b32 v135, 0
    v_lshrrev_b32 v4, 2, v2
    v_lshl_add_u32 v4, v3, 2, v4
    s_lshl_b32 s27, s3, 4
    v_add_u32 v4, s27, v4
    v_mul_u32_u24 v4, 80, v4
    v_and_b32 v6, 3, v1
    v_lshl_add_u32 v10, v6, 3, v4
    v_mov_b32 v140, 0
    v_mov_b32 v141, 0
    v_mov_b32 v142, 0
    v_mov_b32 v143, 0
    v_mov_b32 v144, 0
    v_mov_b32 v145, 0
    v_mov_b32 v146, 0
    v_mov_b32 v147, 0
    ds_read_b64_tr_b16 v[136:137], v10 offset:0
    ds_read_b64_tr_b16 v[138:139], v10 offset:1280
    s_waitcnt lgkmcnt(0)
    v_mfma_f32_16x16x32_bf16 v[140:143], v[136:139], v[100:103], v[140:143]
    ds_read_b64_tr_b16 v[136:137], v10 offset:32
    ds_read_b64_tr_b16 v[138:139], v10 offset:1312
    s_waitcnt lgkmcnt(0)
    v_mfma_f32_16x16x32_bf16 v[144:147], v[136:139], v[100:103], v[144:147]
    ds_read_b64_tr_b16 v[136:137], v10 offset:2560
    ds_read_b64_tr_b16 v[138:139], v10 offset:3840
    s_waitcnt lgkmcnt(0)
    v_mfma_f32_16x16x32_bf16 v[140:143], v[136:139], v[104:107], v[140:143]
    ds_read_b64_tr_b16 v[136:137], v10 offset:2592
    ds_read_b64_tr_b16 v[138:139], v10 offset:3872
    s_waitcnt lgkmcnt(0)
    v_mfma_f32_16x16x32_bf16 v[144:147], v[136:139], v[104:107], v[144:147]
    ds_read_b64_tr_b16 v[136:137], v10 offset:5120
    ds_read_b64_tr_b16 v[138:139], v10 offset:6400
    s_waitcnt lgkmcnt(0)
    v_mfma_f32_16x16x32_bf16 v[140:143], v[136:139], v[108:111], v[140:143]
    ds_read_b64_tr_b16 v[136:137], v10 offset:5152
    ds_read_b64_tr_b16 v[138:139], v10 offset:6432
    s_waitcnt lgkmcnt(0)
    v_mfma_f32_16x16x32_bf16 v[144:147], v[136:139], v[108:111], v[144:147]
    ds_read_b64_tr_b16 v[136:137], v10 offset:7680
    ds_read_b64_tr_b16 v[138:139], v10 offset:8960
    s_waitcnt lgkmcnt(0)
    v_mfma_f32_16x16x32_bf16 v[140:143], v[136:139], v[112:115], v[140:143]
    ds_read_b64_tr_b16 v[136:137], v10 offset:7712
    ds_read_b64_tr_b16 v[138:139], v10 offset:8992
    s_waitcnt lgkmcnt(0)
    v_mfma_f32_16x16x32_bf16 v[144:147], v[136:139], v[112:115], v[144:147]
    ds_read_b64_tr_b16 v[136:137], v10 offset:10240
    ds_read_b64_tr_b16 v[138:139], v10 offset:11520
    s_waitcnt lgkmcnt(0)
    v_mfma_f32_16x16x32_bf16 v[140:143], v[136:139], v[116:119], v[140:143]
    ds_read_b64_tr_b16 v[136:137], v10 offset:10272
    ds_read_b64_tr_b16 v[138:139], v10 offset:11552
    s_waitcnt lgkmcnt(0)
    v_mfma_f32_16x16x32_bf16 v[144:147], v[136:139], v[116:119], v[144:147]
    ds_read_b64_tr_b16 v[136:137], v10 offset:12800
    ds_read_b64_tr_b16 v[138:139], v10 offset:14080
    s_waitcnt lgkmcnt(0)
    v_mfma_f32_16x16x32_bf16 v[140:143], v[136:139], v[120:123], v[140:143]
    ds_read_b64_tr_b16 v[136:137], v10 offset:12832
    ds_read_b64_tr_b16 v[138:139], v10 offset:14112
    s_waitcnt lgkmcnt(0)
    v_mfma_f32_16x16x32_bf16 v[144:147], v[136:139], v[120:123], v[144:147]
    ds_read_b64_tr_b16 v[136:137], v10 offset:15360
    ds_read_b64_tr_b16 v[138:139], v10 offset:16640
    s_waitcnt lgkmcnt(0)
    v_mfma_f32_16x16x32_bf16 v[140:143], v[136:139], v[124:127], v[140:143]
    ds_read_b64_tr_b16 v[136:137], v10 offset:15392
    ds_read_b64_tr_b16 v[138:139], v10 offset:16672
    s_waitcnt lgkmcnt(0)
    v_mfma_f32_16x16x32_bf16 v[144:147], v[136:139], v[124:127], v[144:147]
    ds_read_b64_tr_b16 v[136:137], v10 offset:17920
    ds_read_b64_tr_b16 v[138:139], v10 offset:19200
    s_waitcnt lgkmcnt(0)
    v_mfma_f32_16x16x32_bf16 v[140:143], v[136:139], v[128:131], v[140:143]
    ds_read_b64_tr_b16 v[136:137], v10 offset:17952
    ds_read_b64_tr_b16 v[138:139], v10 offset:19232
    s_waitcnt lgkmcnt(0)
    v_mfma_f32_16x16x32_bf16 v[144:147], v[136:139], v[128:131], v[144:147]
    ds_read_b64_tr_b16 v[136:137], v10 offset:20480
    ds_read_b64_tr_b16 v[138:139], v10 offset:20480
    s_waitcnt lgkmcnt(0)
    v_mfma_f32_16x16x32_bf16 v[140:143], v[136:139], v[132:135], v[140:143]
    ds_read_b64_tr_b16 v[136:137], v10 offset:20512
    ds_read_b64_tr_b16 v[138:139], v10 offset:20512
    s_waitcnt lgkmcnt(0)
    v_mfma_f32_16x16x32_bf16 v[144:147], v[136:139], v[132:135], v[144:147]
    s_nop 7
    s_nop 3
    v_lshlrev_b32 v8, 11, v2
    v_lshl_add_u32 v8, v3, 3, v8
    s_lshl_b32 s27, s23, 11
    s_add_u32 s27, s27, s26
    s_add_u32 s27, s27, 62914560
    v_cvt_pk_bf16_f32 v6, v140, v141
    v_cvt_pk_bf16_f32 v7, v142, v143
    buffer_store_dwordx2 v[6:7], v8, s[4:7], s27 offen offset:0
    s_nop 1
    v_cvt_pk_bf16_f32 v6, v144, v145
    v_cvt_pk_bf16_f32 v7, v146, v147
    buffer_store_dwordx2 v[6:7], v8, s[4:7], s27 offen offset:32
    s_nop 1
attnA_kernel_end:
    s_endpgm
.section .rodata,"a"
.p2align 6
.amdhsa_kernel attnA_kernel
  .amdhsa_next_free_vgpr 148
  .amdhsa_next_free_sgpr 102
  .amdhsa_accum_offset 148
  .amdhsa_group_segment_fixed_size 0
  .amdhsa_kernarg_size 104
  .amdhsa_user_sgpr_count 2
  .amdhsa_user_sgpr_kernarg_segment_ptr 1
  .amdhsa_system_sgpr_workgroup_id_x 1
.end_amdhsa_kernel

.text
.globl attnB_kernel
.p2align 8
.type attnB_kernel,@function
attnB_kernel:
    s_cmp_ge_u32 s2, 512
    s_cbranch_scc1 attnB_kernel_end
    s_load_dwordx2 s[64:65], s[0:1], 96
    v_and_b32 v1, 63, v0
    v_lshrrev_b32 v4, 6, v0
    s_nop 1
    v_readfirstlane_b32 s3, v4
    v_and_b32 v2, 15, v1
    v_lshrrev_b32 v3, 4, v1
    s_lshr_b32 s20, s2, 3
    s_and_b32 s21, s2, 7
    s_lshl_b32 s21, s21, 2
    s_add_u32 s21, s21, s3
    s_waitcnt lgkmcnt(0)
    s_mov_b32 s4, s64
    s_and_b32 s5, s65, 0xffff
    s_mov_b32 s6, 0x10000000
    s_mov_b32 s7, 0x00020000
    s_mov_b32 s24, 24576
    v_mul_lo_u32 v9, v2, s24
    v_lshl_add_u32 v9, v3, 4, v9
    s_mul_i32 s25, s20, 786432
    s_lshl_b32 s26, s21, 8
    s_add_u32 s25, s25, s26
    s_add_u32 s25, s25, 12582912
    s_add_u32 s27, s25, 0
    buffer_load_dwordx4 v[16:19], v9, s[4:7], s27 offen offset:0
    buffer_load_dwordx4 v[20:23], v9, s[4:7], s27 offen offset:64
    buffer_load_dwordx4 v[24:27], v9, s[4:7], s27 offen offset:128
    buffer_load_dwordx4 v[28:31], v9, s[4:7], s27 offen offset:192
    s_add_u32 s27, s25, 393216
    buffer_load_dwordx4 v[32:35], v9, s[4:7], s27 offen offset:0
    buffer_load_dwordx4 v[36:39], v9, s[4:7], s27 offen offset:64
    buffer_load_dwordx4 v[40:43], v9, s[4:7], s27 offen offset:128
    buffer_load_dwordx4 v[44:47], v9, s[4:7], s27 offen offset:192
    s_mul_i32 s28, s3, 13056
    v_lshrrev_b32 v4, 4, v1
    v_mul_lo_u32 v6, v4, s24
    v_lshl_add_u32 v6, v2, 4, v6
    v_mul_u32_u24 v12, 272, v4
    v_lshl_add_u32 v12, v2, 4, v12
    v_add_u32 v12, s28, v12
    s_add_u32 s27, s25, 16384
    buffer_load_dwordx4 v[48:51], v6, s[4:7], s27 offen
    s_add_u32 s27, s27, 98304
    buffer_load_dwordx4 v[52:55], v6, s[4:7], s27 offen
    s_add_u32 s27, s27, 98304
    buffer_load_dwordx4 v[56:59], v6, s[4:7], s27 offen
    s_add_u32 s27, s27, 98304
    buffer_load_dwordx4 v[60:63], v6, s[4:7], s27 offen
    s_add_u32 s27, s27, 98304
    s_waitcnt vmcnt(0)
    ds_write_b128 v12, v[48:51] offset:0
    ds_write_b128 v12, v[52:55] offset:1088
    ds_write_b128 v12, v[56:59] offset:2176
    ds_write_b128 v12, v[60:63] offset:3264
    buffer_load_dwordx4 v[48:51], v6, s[4:7], s27 offen
    s_add_u32 s27, s27, 98304
    buffer_load_dwordx4 v[52:55], v6, s[4:7], s27 offen
    s_add_u32 s27, s27, 98304
    buffer_load_dwordx4 v[56:59], v6, s[4:7], s27 offen
    s_add_u32 s27, s27, 98304
    buffer_load_dwordx4 v[60:63], v6, s[4:7], s27 offen
    s_add_u32 s27, s27, 98304
    s_waitcnt vmcnt(0)
    ds_write_b128 v12, v[48:51] offset:4352
    ds_write_b128 v12, v[52:55] offset:5440
    ds_write_b128 v12, v[56:59] offset:6528
    ds_write_b128 v12, v[60:63] offset:7616
    v_lshlrev_b32 v7, 14, v4
    v_lshl_add_u32 v7, v2, 4, v7
    s_lshl_b32 s27, s20, 17
    s_add_u32 s27, s27, s26
    s_add_u32 s29, s27, 83886080
    s_add_u32 s27, s29, 8192
    buffer_load_dwordx4 v[48:51], v7, s[4:7], s27 offen
    s_add_u32 s27, s27, 65536
    buffer_load_dwordx4 v[52:55], v7, s[4:7], s27 offen
    s_add_u32 s27, s27, 65536
    v_mov_b32 v56, 0
    v_mov_b32 v57, 0
    v_mov_b32 v58, 0
    v_mov_b32 v59, 0
    s_waitcnt vmcnt(0)
    ds_write_b128 v12, v[48:51] offset:8704
    ds_write_b128 v12, v[52:55] offset:9792
    ds_write_b128 v12, v[56:59] offset:10880
    ds_write_b128 v12, v[56:59] offset:11968
    v_lshrrev_b32 v4, 2, v2
    v_lshl_add_u32 v4, v3, 2, v4
    v_mul_u32_u24 v4, 272, v4
    v_and_b32 v6, 3, v1
    v_lshl_add_u32 v4, v6, 3, v4
    v_add_u32 v11, s28, v4
    v_and_b32 v4, 7, v2
    v_lshlrev_b32 v4, 14, v4
    v_lshl_add_u32 v10, v3, 4, v4
    v_mov_b32 v64, 0
    v_mov_b32 v65, 0
    v_mov_b32 v66, 0
    v_mov_b32 v67, 0
    v_mov_b32 v68, 0
    v_mov_b32 v69, 0
    v_mov_b32 v70, 0
    v_mov_b32 v71, 0
    v_mov_b32 v72, 0
    v_mov_b32 v73, 0
    v_mov_b32 v74, 0
    v_mov_b32 v75, 0
    s_add_u32 s27, s25, 8192
    buffer_load_dwordx4 v[48:51], v9, s[4:7], s27 offen offset:0
    buffer_load_dwordx4 v[52:55], v9, s[4:7], s27 offen offset:64
    buffer_load_dwordx4 v[56:59], v9, s[4:7], s27 offen offset:128
    buffer_load_dwordx4 v[60:63], v9, s[4:7], s27 offen offset:192
    s_waitcnt vmcnt(0)
    v_mfma_f32_16x16x32_bf16 v[64:67], v[48:51], v[16:19], v[64:67]
    v_mfma_f32_16x16x32_bf16 v[64:67], v[52:55], v[20:23], v[64:67]
    v_mfma_f32_16x16x32_bf16 v[64:67], v[56:59], v[24:27], v[64:67]
    v_mfma_f32_16x16x32_bf16 v[64:67], v[60:63], v[28:31], v[64:67]
    s_add_u32 s27, s25, 401408
    buffer_load_dwordx4 v[48:51], v9, s[4:7], s27 offen offset:0
    buffer_load_dwordx4 v[52:55], v9, s[4:7], s27 offen offset:64
    buffer_load_dwordx4 v[56:59], v9, s[4:7], s27 offen offset:128
    buffer_load_dwordx4 v[60:63], v9, s[4:7], s27 offen offset:192
    s_waitcnt vmcnt(0)
    v_mfma_f32_16x16x32_bf16 v[68:71], v[48:51], v[16:19], v[68:71]
    v_mfma_f32_16x16x32_bf16 v[68:71], v[52:55], v[20:23], v[68:71]
    v_mfma_f32_16x16x32_bf16 v[68:71], v[56:59], v[24:27], v[68:71]
    v_mfma_f32_16x16x32_bf16 v[68:71], v[60:63], v[28:31], v[68:71]
    buffer_load_dwordx4 v[48:51], v10, s[4:7], s29 offen offset:0
    buffer_load_dwordx4 v[52:55], v10, s[4:7], s29 offen offset:64
    buffer_load_dwordx4 v[56:59], v10, s[4:7], s29 offen offset:128
    buffer_load_dwordx4 v[60:63], v10, s[4:7], s29 offen offset:192
    s_waitcnt vmcnt(0)
    v_mfma_f32_16x16x32_bf16 v[72:75], v[48:51], v[16:19], v[72:75]
    v_mfma_f32_16x16x32_bf16 v[72:75], v[52:55], v[20:23], v[72:75]
    v_mfma_f32_16x16x32_bf16 v[72:75], v[56:59], v[24:27], v[72:75]
    v_mfma_f32_16x16x32_bf16 v[72:75], v[60:63], v[28:31], v[72:75]
    s_nop 7
    s_nop 3
    s_mov_b32 s24, 0x3db504f3
    v_cvt_pk_bf16_f32 v64, v64, v64
    v_lshlrev_b32 v64, 16, v64
    v_mul_f32 v64, s24, v64
    v_cvt_pk_bf16_f32 v64, v64, v64
    v_lshlrev_b32 v64, 16, v64
    v_cvt_pk_bf16_f32 v65, v65, v65
    v_lshlrev_b32 v65, 16, v65
    v_mul_f32 v65, s24, v65
    v_cvt_pk_bf16_f32 v65, v65, v65
    v_lshlrev_b32 v65, 16, v65
    v_cvt_pk_bf16_f32 v66, v66, v66
    v_lshlrev_b32 v66, 16, v66
    v_mul_f32 v66, s24, v66
    v_cvt_pk_bf16_f32 v66, v66, v66
    v_lshlrev_b32 v66, 16, v66
    v_cvt_pk_bf16_f32 v67, v67, v67
    v_lshlrev_b32 v67, 16, v67
    v_mul_f32 v67, s24, v67
    v_cvt_pk_bf16_f32 v67, v67, v67
    v_lshlrev_b32 v67, 16, v67
    v_cvt_pk_bf16_f32 v68, v68, v68
    v_lshlrev_b32 v68, 16, v68
    v_mul_f32 v68, s24, v68
    v_cvt_pk_bf16_f32 v68, v68, v68
    v_lshlrev_b32 v68, 16, v68
    v_cvt_pk_bf16_f32 v69, v69, v69
    v_lshlrev_b32 v69, 16, v69
    v_mul_f32 v69, s24, v69
    v_cvt_pk_bf16_f32 v69, v69, v69
    v_lshlrev_b32 v69, 16, v69
    v_cvt_pk_bf16_f32 v70, v70, v70
    v_lshlrev_b32 v70, 16, v70
    v_mul_f32 v70, s24, v70
    v_cvt_pk_bf16_f32 v70, v70, v70
    v_lshlrev_b32 v70, 16, v70
    v_cvt_pk_bf16_f32 v71, v71, v71
    v_lshlrev_b32 v71, 16, v71
    v_mul_f32 v71, s24, v71
    v_cvt_pk_bf16_f32 v71, v71, v71
    v_lshlrev_b32 v71, 16, v71
    v_cvt_pk_bf16_f32 v72, v72, v72
    v_lshlrev_b32 v72, 16, v72
    v_mul_f32 v72, s24, v72
    v_cvt_pk_bf16_f32 v72, v72, v72
    v_lshlrev_b32 v72, 16, v72
    v_cvt_pk_bf16_f32 v73, v73, v73
    v_lshlrev_b32 v73, 16, v73
    v_mul_f32 v73, s24, v73
    v_cvt_pk_bf16_f32 v73, v73, v73
    v_lshlrev_b32 v73, 16, v73
    v_cvt_pk_bf16_f32 v74, v74, v74
    v_lshlrev_b32 v74, 16, v74
    v_mul_f32 v74, s24, v74
    v_cvt_pk_bf16_f32 v74, v74, v74
    v_lshlrev_b32 v74, 16, v74
    v_cvt_pk_bf16_f32 v75, v75, v75
    v_lshlrev_b32 v75, 16, v75
    v_mul_f32 v75, s24, v75
    v_cvt_pk_bf16_f32 v75, v75, v75
    v_lshlrev_b32 v75, 16, v75
    s_mov_b32 s24, 0xf149f2ca
    v_lshl_add_u32 v4, v3, 2, 0
    v_cmp_gt_i32 vcc, v4, v2
    v_mov_b32 v6, s24
    v_cndmask_b32 v64, v64, v6, vcc
    v_lshl_add_u32 v4, v3, 2, 1
    v_cmp_gt_i32 vcc, v4, v2
    v_mov_b32 v6, s24
    v_cndmask_b32 v65, v65, v6, vcc
    v_lshl_add_u32 v4, v3, 2, 2
    v_cmp_gt_i32 vcc, v4, v2
    v_mov_b32 v6, s24
    v_cndmask_b32 v66, v66, v6, vcc
    v_lshl_add_u32 v4, v3, 2, 3
    v_cmp_gt_i32 vcc, v4, v2
    v_mov_b32 v6, s24
    v_cndmask_b32 v67, v67, v6, vcc
    v_lshl_add_u32 v4, v3, 2, 16
    v_cmp_gt_i32 vcc, v4, v2
    v_mov_b32 v6, s24
    v_cndmask_b32 v68, v68, v6, vcc
    v_lshl_add_u32 v4, v3, 2, 17
    v_cmp_gt_i32 vcc, v4, v2
    v_mov_b32 v6, s24
    v_cndmask_b32 v69, v69, v6, vcc
    v_lshl_add_u32 v4, v3, 2, 18
    v_cmp_gt_i32 vcc, v4, v2
    v_mov_b32 v6, s24
    v_cndmask_b32 v70, v70, v6, vcc
    v_lshl_add_u32 v4, v3, 2, 19
    v_cmp_gt_i32 vcc, v4, v2
    v_mov_b32 v6, s24
    v_cndmask_b32 v71, v71, v6, vcc
    v_cmp_le_u32 vcc, 2, v3
    v_mov_b32 v6, s24
    v_cndmask_b32 v72, v72, v6, vcc
    v_cndmask_b32 v73, v73, v6, vcc
    v_cndmask_b32 v74, v74, v6, vcc
    v_cndmask_b32 v75, v75, v6, vcc
    v_max3_f32 v4, v64, v65, v66
    v_max3_f32 v4, v4, v67, v68
    v_max3_f32 v4, v4, v69, v70
    v_max3_f32 v4, v4, v71, v72
    v_max3_f32 v4, v4, v73, v74
    v_max_f32 v4, v4, v75
    v_xor_b32 v6, 16, v1
    v_lshlrev_b32 v6, 2, v6
    ds_bpermute_b32 v7, v6, v4
    s_waitcnt lgkmcnt(0)
    v_max_f32 v4, v4, v7
    v_xor_b32 v6, 32, v1
    v_lshlrev_b32 v6, 2, v6
    ds_bpermute_b32 v7, v6, v4
    s_waitcnt lgkmcnt(0)
    v_max_f32 v4, v4, v7
    s_mov_b32 s24, 0x3fb8aa3b
    v_sub_f32 v64, v64, v4
    v_mul_f32 v64, s24, v64
    v_exp_f32 v64, v64
    v_sub_f32 v65, v65, v4
    v_mul_f32 v65, s24, v65
    v_exp_f32 v65, v65
    v_sub_f32 v66, v66, v4
    v_mul_f32 v66, s24, v66
    v_exp_f32 v66, v66
    v_sub_f32 v67, v67, v4
    v_mul_f32 v67, s24, v67
    v_exp_f32 v67, v67
    v_sub_f32 v68, v68, v4
    v_mul_f32 v68, s24, v68
    v_exp_f32 v68, v68
    v_sub_f32 v69, v69, v4
    v_mul_f32 v69, s24, v69
    v_exp_f32 v69, v69
    v_sub_f32 v70, v70, v4
    v_mul_f32 v70, s24, v70
    v_exp_f32 v70, v70
    v_sub_f32 v71, v71, v4
    v_mul_f32 v71, s24, v71
    v_exp_f32 v71, v71
    v_sub_f32 v72, v72, v4
    v_mul_f32 v72, s24, v72
    v_exp_f32 v72, v72
    v_sub_f32 v73, v73, v4
    v_mul_f32 v73, s24, v73
    v_exp_f32 v73, v73
    v_sub_f32 v74, v74, v4
    v_mul_f32 v74, s24, v74
    v_exp_f32 v74, v74
    v_sub_f32 v75, v75, v4
    v_mul_f32 v75, s24, v75
    v_exp_f32 v75, v75
    s_nop 0
    v_add_f32 v4, v64, v65
    v_add_f32 v4, v4, v66
    v_add_f32 v4, v4, v67
    v_add_f32 v4, v4, v68
    v_add_f32 v4, v4, v69
    v_add_f32 v4, v4, v70
    v_add_f32 v4, v4, v71
    v_add_f32 v4, v4, v72
    v_add_f32 v4, v4, v73
    v_add_f32 v4, v4, v74
    v_add_f32 v4, v4, v75
    v_xor_b32 v6, 16, v1
    v_lshlrev_b32 v6, 2, v6
    ds_bpermute_b32 v7, v6, v4
    s_waitcnt lgkmcnt(0)
    v_add_f32 v4, v4, v7
    v_xor_b32 v6, 32, v1
    v_lshlrev_b32 v6, 2, v6
    ds_bpermute_b32 v7, v6, v4
    s_waitcnt lgkmcnt(0)
    v_add_f32 v4, v4, v7
    v_rcp_f32 v4, v4
    s_nop 0
    v_mul_f32 v64, v64, v4
    v_mul_f32 v65, v65, v4
    v_mul_f32 v66, v66, v4
    v_mul_f32 v67, v67, v4
    v_mul_f32 v68, v68, v4
    v_mul_f32 v69, v69, v4
    v_mul_f32 v70, v70, v4
    v_mul_f32 v71, v71, v4
    v_mul_f32 v72, v72, v4
    v_mul_f32 v73, v73, v4
    v_mul_f32 v74, v74, v4
    v_mul_f32 v75, v75, v4
    v_cvt_pk_bf16_f32 v76, v64, v65
    v_cvt_pk_bf16_f32 v77, v66, v67
    v_cvt_pk_bf16_f32 v78, v68, v69
    v_cvt_pk_bf16_f32 v79, v70, v71
    v_cvt_pk_bf16_f32 v80, v72, v73
    v_cvt_pk_bf16_f32 v81, v74, v75
    v_mov_b32 v82, 0
    v_mov_b32 v83, 0
    v_mov_b32 v64, 0
    v_mov_b32 v65, 0
    v_mov_b32 v66, 0
    v_mov_b32 v67, 0
    v_mov_b32 v68, 0
    v_mov_b32 v69, 0
    v_mov_b32 v70, 0
    v_mov_b32 v71, 0
    v_mov_b32 v72, 0
    v_mov_b32 v73, 0
    v_mov_b32 v74, 0
    v_mov_b32 v75, 0
    s_add_u32 s27, s25, 8192
    buffer_load_dwordx4 v[48:51], v9, s[4:7], s27 offen offset:0
    buffer_load_dwordx4 v[52:55], v9, s[4:7], s27 offen offset:64
    buffer_load_dwordx4 v[56:59], v9, s[4:7], s27 offen offset:128
    buffer_load_dwordx4 v[60:63], v9, s[4:7], s27 offen offset:192
    s_waitcnt vmcnt(0)
    v_mfma_f32_16x16x32_bf16 v[64:67], v[48:51], v[32:35], v[64:67]
    v_mfma_f32_16x16x32_bf16 v[64:67], v[52:55], v[36:39], v[64:67]
    v_mfma_f32_16x16x32_bf16 v[64:67], v[56:59], v[40:43], v[64:67]
    v_mfma_f32_16x16x32_bf16 v[64:67], v[60:63], v[44:47], v[64:67]
    s_add_u32 s27, s25, 401408
    buffer_load_dwordx4 v[48:51], v9, s[4:7], s27 offen offset:0
    buffer_load_dwordx4 v[52:55], v9, s[4:7], s27 offen offset:64
    buffer_load_dwordx4 v[56:59], v9, s[4:7], s27 offen offset:128
    buffer_load_dwordx4 v[60:63], v9, s[4:7], s27 offen offset:192
    s_waitcnt vmcnt(0)
    v_mfma_f32_16x16x32_bf16 v[68:71], v[48:51], v[32:35], v[68:71]
    v_mfma_f32_16x16x32_bf16 v[68:71], v[52:55], v[36:39], v[68:71]
    v_mfma_f32_16x16x32_bf16 v[68:71], v[56:59], v[40:43], v[68:71]
    v_mfma_f32_16x16x32_bf16 v[68:71], v[60:63], v[44:47], v[68:71]
    buffer_load_dwordx4 v[48:51], v10, s[4:7], s29 offen offset:0
    buffer_load_dwordx4 v[52:55], v10, s[4:7], s29 offen offset:64
    buffer_load_dwordx4 v[56:59], v10, s[4:7], s29 offen offset:128
    buffer_load_dwordx4 v[60:63], v10, s[4:7], s29 offen offset:192
    s_waitcnt vmcnt(0)
    v_mfma_f32_16x16x32_bf16 v[72:75], v[48:51], v[32:35], v[72:75]
    v_mfma_f32_16x16x32_bf16 v[72:75], v[52:55], v[36:39], v[72:75]
    v_mfma_f32_16x16x32_bf16 v[72:75], v[56:59], v[40:43], v[72:75]
    v_mfma_f32_16x16x32_bf16 v[72:75], v[60:63], v[44:47], v[72:75]
    s_nop 7
    s_nop 3
    s_mov_b32 s24, 0x3db504f3
    v_cvt_pk_bf16_f32 v64, v64, v64
    v_lshlrev_b32 v64, 16, v64
    v_mul_f32 v64, s24, v64
    v_cvt_pk_bf16_f32 v64, v64, v64
    v_lshlrev_b32 v64, 16, v64
    v_cvt_pk_bf16_f32 v65, v65, v65
    v_lshlrev_b32 v65, 16, v65
    v_mul_f32 v65, s24, v65
    v_cvt_pk_bf16_f32 v65, v65, v65
    v_lshlrev_b32 v65, 16, v65
    v_cvt_pk_bf16_f32 v66, v66, v66
    v_lshlrev_b32 v66, 16, v66
    v_mul_f32 v66, s24, v66
    v_cvt_pk_bf16_f32 v66, v66, v66
    v_lshlrev_b32 v66, 16, v66
    v_cvt_pk_bf16_f32 v67, v67, v67
    v_lshlrev_b32 v67, 16, v67
    v_mul_f32 v67, s24, v67
    v_cvt_pk_bf16_f32 v67, v67, v67
    v_lshlrev_b32 v67, 16, v67
    v_cvt_pk_bf16_f32 v68, v68, v68
    v_lshlrev_b32 v68, 16, v68
    v_mul_f32 v68, s24, v68
    v_cvt_pk_bf16_f32 v68, v68, v68
    v_lshlrev_b32 v68, 16, v68
    v_cvt_pk_bf16_f32 v69, v69, v69
    v_lshlrev_b32 v69, 16, v69
    v_mul_f32 v69, s24, v69
    v_cvt_pk_bf16_f32 v69, v69, v69
    v_lshlrev_b32 v69, 16, v69
    v_cvt_pk_bf16_f32 v70, v70, v70
    v_lshlrev_b32 v70, 16, v70
    v_mul_f32 v70, s24, v70
    v_cvt_pk_bf16_f32 v70, v70, v70
    v_lshlrev_b32 v70, 16, v70
    v_cvt_pk_bf16_f32 v71, v71, v71
    v_lshlrev_b32 v71, 16, v71
    v_mul_f32 v71, s24, v71
    v_cvt_pk_bf16_f32 v71, v71, v71
    v_lshlrev_b32 v71, 16, v71
    v_cvt_pk_bf16_f32 v72, v72, v72
    v_lshlrev_b32 v72, 16, v72
    v_mul_f32 v72, s24, v72
    v_cvt_pk_bf16_f32 v72, v72, v72
    v_lshlrev_b32 v72, 16, v72
    v_cvt_pk_bf16_f32 v73, v73, v73
    v_lshlrev_b32 v73, 16, v73
    v_mul_f32 v73, s24, v73
    v_cvt_pk_bf16_f32 v73, v73, v73
    v_lshlrev_b32 v73, 16, v73
    v_cvt_pk_bf16_f32 v74, v74, v74
    v_lshlrev_b32 v74, 16, v74
    v_mul_f32 v74, s24, v74
    v_cvt_pk_bf16_f32 v74, v74, v74
    v_lshlrev_b32 v74, 16, v74
    v_cvt_pk_bf16_f32 v75, v75, v75
    v_lshlrev_b32 v75, 16, v75
    v_mul_f32 v75, s24, v75
    v_cvt_pk_bf16_f32 v75, v75, v75
    v_lshlrev_b32 v75, 16, v75
    s_mov_b32 s24, 0xf149f2ca
    v_lshl_add_u32 v4, v3, 2, -16
    v_cmp_gt_i32 vcc, v4, v2
    v_mov_b32 v6, s24
    v_cndmask_b32 v64, v64, v6, vcc
    v_lshl_add_u32 v4, v3, 2, -15
    v_cmp_gt_i32 vcc, v4, v2
    v_mov_b32 v6, s24
    v_cndmask_b32 v65, v65, v6, vcc
    v_lshl_add_u32 v4, v3, 2, -14
    v_cmp_gt_i32 vcc, v4, v2
    v_mov_b32 v6, s24
    v_cndmask_b32 v66, v66, v6, vcc
    v_lshl_add_u32 v4, v3, 2, -13
    v_cmp_gt_i32 vcc, v4, v2
    v_mov_b32 v6, s24
    v_cndmask_b32 v67, v67, v6, vcc
    v_lshl_add_u32 v4, v3, 2, 0
    v_cmp_gt_i32 vcc, v4, v2
    v_mov_b32 v6, s24
    v_cndmask_b32 v68, v68, v6, vcc
    v_lshl_add_u32 v4, v3, 2, 1
    v_cmp_gt_i32 vcc, v4, v2
    v_mov_b32 v6, s24
    v_cndmask_b32 v69, v69, v6, vcc
    v_lshl_add_u32 v4, v3, 2, 2
    v_cmp_gt_i32 vcc, v4, v2
    v_mov_b32 v6, s24
    v_cndmask_b32 v70, v70, v6, vcc
    v_lshl_add_u32 v4, v3, 2, 3
    v_cmp_gt_i32 vcc, v4, v2
    v_mov_b32 v6, s24
    v_cndmask_b32 v71, v71, v6, vcc
    v_cmp_le_u32 vcc, 2, v3
    v_mov_b32 v6, s24
    v_cndmask_b32 v72, v72, v6, vcc
    v_cndmask_b32 v73, v73, v6, vcc
    v_cndmask_b32 v74, v74, v6, vcc
    v_cndmask_b32 v75, v75, v6, vcc
    v_max3_f32 v4, v64, v65, v66
    v_max3_f32 v4, v4, v67, v68
    v_max3_f32 v4, v4, v69, v70
    v_max3_f32 v4, v4, v71, v72
    v_max3_f32 v4, v4, v73, v74
    v_max_f32 v4, v4, v75
    v_xor_b32 v6, 16, v1
    v_lshlrev_b32 v6, 2, v6
    ds_bpermute_b32 v7, v6, v4
    s_waitcnt lgkmcnt(0)
    v_max_f32 v4, v4, v7
    v_xor_b32 v6, 32, v1
    v_lshlrev_b32 v6, 2, v6
    ds_bpermute_b32 v7, v6, v4
    s_waitcnt lgkmcnt(0)
    v_max_f32 v4, v4, v7
    s_mov_b32 s24, 0x3fb8aa3b
    v_sub_f32 v64, v64, v4
    v_mul_f32 v64, s24, v64
    v_exp_f32 v64, v64
    v_sub_f32 v65, v65, v4
    v_mul_f32 v65, s24, v65
    v_exp_f32 v65, v65
    v_sub_f32 v66, v66, v4
    v_mul_f32 v66, s24, v66
    v_exp_f32 v66, v66
    v_sub_f32 v67, v67, v4
    v_mul_f32 v67, s24, v67
    v_exp_f32 v67, v67
    v_sub_f32 v68, v68, v4
    v_mul_f32 v68, s24, v68
    v_exp_f32 v68, v68
    v_sub_f32 v69, v69, v4
    v_mul_f32 v69, s24, v69
    v_exp_f32 v69, v69
    v_sub_f32 v70, v70, v4
    v_mul_f32 v70, s24, v70
    v_exp_f32 v70, v70
    v_sub_f32 v71, v71, v4
    v_mul_f32 v71, s24, v71
    v_exp_f32 v71, v71
    v_sub_f32 v72, v72, v4
    v_mul_f32 v72, s24, v72
    v_exp_f32 v72, v72
    v_sub_f32 v73, v73, v4
    v_mul_f32 v73, s24, v73
    v_exp_f32 v73, v73
    v_sub_f32 v74, v74, v4
    v_mul_f32 v74, s24, v74
    v_exp_f32 v74, v74
    v_sub_f32 v75, v75, v4
    v_mul_f32 v75, s24, v75
    v_exp_f32 v75, v75
    s_nop 0
    v_add_f32 v4, v64, v65
    v_add_f32 v4, v4, v66
    v_add_f32 v4, v4, v67
    v_add_f32 v4, v4, v68
    v_add_f32 v4, v4, v69
    v_add_f32 v4, v4, v70
    v_add_f32 v4, v4, v71
    v_add_f32 v4, v4, v72
    v_add_f32 v4, v4, v73
    v_add_f32 v4, v4, v74
    v_add_f32 v4, v4, v75
    v_xor_b32 v6, 16, v1
    v_lshlrev_b32 v6, 2, v6
    ds_bpermute_b32 v7, v6, v4
    s_waitcnt lgkmcnt(0)
    v_add_f32 v4, v4, v7
    v_xor_b32 v6, 32, v1
    v_lshlrev_b32 v6, 2, v6
    ds_bpermute_b32 v7, v6, v4
    s_waitcnt lgkmcnt(0)
    v_add_f32 v4, v4, v7
    v_rcp_f32 v4, v4
    s_nop 0
    v_mul_f32 v64, v64, v4
    v_mul_f32 v65, v65, v4
    v_mul_f32 v66, v66, v4
    v_mul_f32 v67, v67, v4
    v_mul_f32 v68, v68, v4
    v_mul_f32 v69, v69, v4
    v_mul_f32 v70, v70, v4
    v_mul_f32 v71, v71, v4
    v_mul_f32 v72, v72, v4
    v_mul_f32 v73, v73, v4
    v_mul_f32 v74, v74, v4
    v_mul_f32 v75, v75, v4
    v_cvt_pk_bf16_f32 v84, v64, v65
    v_cvt_pk_bf16_f32 v85, v66, v67
    v_cvt_pk_bf16_f32 v86, v68, v69
    v_cvt_pk_bf16_f32 v87, v70, v71
    v_cvt_pk_bf16_f32 v88, v72, v73
    v_cvt_pk_bf16_f32 v89, v74, v75
    v_mov_b32 v90, 0
    v_mov_b32 v91, 0
    s_waitcnt lgkmcnt(0)
    v_lshlrev_b32 v8, 13, v2
    v_lshl_add_u32 v8, v3, 3, v8
    s_lshl_b32 s27, s20, 18
    s_add_u32 s27, s27, s26
    s_add_u32 s27, s27, 67108864
    ds_read_b64_tr_b16 v[92:93], v11 offset:0
    ds_read_b64_tr_b16 v[94:95], v11 offset:4352
    ds_read_b64_tr_b16 v[96:97], v11 offset:8704
    ds_read_b64_tr_b16 v[98:99], v11 offset:8704
    s_waitcnt lgkmcnt(0)
    v_mfma_f32_16x16x32_bf16 v[100:103], v[92:95], v[76:79], 0
    v_mfma_f32_16x16x32_bf16 v[100:103], v[96:99], v[80:83], v[100:103]
    s_nop 7
    s_nop 3
    v_cvt_pk_bf16_f32 v6, v100, v101
    v_cvt_pk_bf16_f32 v7, v102, v103
    s_add_u32 s30, s27, 0
    buffer_store_dwordx2 v[6:7], v8, s[4:7], s30 offen offset:0
    s_nop 1
    v_mfma_f32_16x16x32_bf16 v[100:103], v[92:95], v[84:87], 0
    v_mfma_f32_16x16x32_bf16 v[100:103], v[96:99], v[88:91], v[100:103]
    s_nop 7
    s_nop 3
    v_cvt_pk_bf16_f32 v6, v100, v101
    v_cvt_pk_bf16_f32 v7, v102, v103
    s_add_u32 s30, s27, 131072
    buffer_store_dwordx2 v[6:7], v8, s[4:7], s30 offen offset:0
    s_nop 1
    ds_read_b64_tr_b16 v[92:93], v11 offset:32
    ds_read_b64_tr_b16 v[94:95], v11 offset:4384
    ds_read_b64_tr_b16 v[96:97], v11 offset:8736
    ds_read_b64_tr_b16 v[98:99], v11 offset:8736
    s_waitcnt lgkmcnt(0)
    v_mfma_f32_16x16x32_bf16 v[100:103], v[92:95], v[76:79], 0
    v_mfma_f32_16x16x32_bf16 v[100:103], v[96:99], v[80:83], v[100:103]
    s_nop 7
    s_nop 3
    v_cvt_pk_bf16_f32 v6, v100, v101
    v_cvt_pk_bf16_f32 v7, v102, v103
    s_add_u32 s30, s27, 0
    buffer_store_dwordx2 v[6:7], v8, s[4:7], s30 offen offset:32
    s_nop 1
    v_mfma_f32_16x16x32_bf16 v[100:103], v[92:95], v[84:87], 0
    v_mfma_f32_16x16x32_bf16 v[100:103], v[96:99], v[88:91], v[100:103]
    s_nop 7
    s_nop 3
    v_cvt_pk_bf16_f32 v6, v100, v101
    v_cvt_pk_bf16_f32 v7, v102, v103
    s_add_u32 s30, s27, 131072
    buffer_store_dwordx2 v[6:7], v8, s[4:7], s30 offen offset:32
    s_nop 1
    ds_read_b64_tr_b16 v[92:93], v11 offset:64
    ds_read_b64_tr_b16 v[94:95], v11 offset:4416
    ds_read_b64_tr_b16 v[96:97], v11 offset:8768
    ds_read_b64_tr_b16 v[98:99], v11 offset:8768
    s_waitcnt lgkmcnt(0)
    v_mfma_f32_16x16x32_bf16 v[100:103], v[92:95], v[76:79], 0
    v_mfma_f32_16x16x32_bf16 v[100:103], v[96:99], v[80:83], v[100:103]
    s_nop 7
    s_nop 3
    v_cvt_pk_bf16_f32 v6, v100, v101
    v_cvt_pk_bf16_f32 v7, v102, v103
    s_add_u32 s30, s27, 0
    buffer_store_dwordx2 v[6:7], v8, s[4:7], s30 offen offset:64
    s_nop 1
    v_mfma_f32_16x16x32_bf16 v[100:103], v[92:95], v[84:87], 0
    v_mfma_f32_16x16x32_bf16 v[100:103], v[96:99], v[88:91], v[100:103]
    s_nop 7
    s_nop 3
    v_cvt_pk_bf16_f32 v6, v100, v101
    v_cvt_pk_bf16_f32 v7, v102, v103
    s_add_u32 s30, s27, 131072
    buffer_store_dwordx2 v[6:7], v8, s[4:7], s30 offen offset:64
    s_nop 1
    ds_read_b64_tr_b16 v[92:93], v11 offset:96
    ds_read_b64_tr_b16 v[94:95], v11 offset:4448
    ds_read_b64_tr_b16 v[96:97], v11 offset:8800
    ds_read_b64_tr_b16 v[98:99], v11 offset:8800
    s_waitcnt lgkmcnt(0)
    v_mfma_f32_16x16x32_bf16 v[100:103], v[92:95], v[76:79], 0
    v_mfma_f32_16x16x32_bf16 v[100:103], v[96:99], v[80:83], v[100:103]
    s_nop 7
    s_nop 3
    v_cvt_pk_bf16_f32 v6, v100, v101
    v_cvt_pk_bf16_f32 v7, v102, v103
    s_add_u32 s30, s27, 0
    buffer_store_dwordx2 v[6:7], v8, s[4:7], s30 offen offset:96
    s_nop 1
    v_mfma_f32_16x16x32_bf16 v[100:103], v[92:95], v[84:87], 0
    v_mfma_f32_16x16x32_bf16 v[100:103], v[96:99], v[88:91], v[100:103]
    s_nop 7
    s_nop 3
    v_cvt_pk_bf16_f32 v6, v100, v101
    v_cvt_pk_bf16_f32 v7, v102, v103
    s_add_u32 s30, s27, 131072
    buffer_store_dwordx2 v[6:7], v8, s[4:7], s30 offen offset:96
    s_nop 1
    ds_read_b64_tr_b16 v[92:93], v11 offset:128
    ds_read_b64_tr_b16 v[94:95], v11 offset:4480
    ds_read_b64_tr_b16 v[96:97], v11 offset:8832
    ds_read_b64_tr_b16 v[98:99], v11 offset:8832
    s_waitcnt lgkmcnt(0)
    v_mfma_f32_16x16x32_bf16 v[100:103], v[92:95], v[76:79], 0
    v_mfma_f32_16x16x32_bf16 v[100:103], v[96:99], v[80:83], v[100:103]
    s_nop 7
    s_nop 3
    v_cvt_pk_bf16_f32 v6, v100, v101
    v_cvt_pk_bf16_f32 v7, v102, v103
    s_add_u32 s30, s27, 0
    buffer_store_dwordx2 v[6:7], v8, s[4:7], s30 offen offset:128
    s_nop 1
    v_mfma_f32_16x16x32_bf16 v[100:103], v[92:95], v[84:87], 0
    v_mfma_f32_16x16x32_bf16 v[100:103], v[96:99], v[88:91], v[100:103]
    s_nop 7
    s_nop 3
    v_cvt_pk_bf16_f32 v6, v100, v101
    v_cvt_pk_bf16_f32 v7, v102, v103
    s_add_u32 s30, s27, 131072
    buffer_store_dwordx2 v[6:7], v8, s[4:7], s30 offen offset:128
    s_nop 1
    ds_read_b64_tr_b16 v[92:93], v11 offset:160
    ds_read_b64_tr_b16 v[94:95], v11 offset:4512
    ds_read_b64_tr_b16 v[96:97], v11 offset:8864
    ds_read_b64_tr_b16 v[98:99], v11 offset:8864
    s_waitcnt lgkmcnt(0)
    v_mfma_f32_16x16x32_bf16 v[100:103], v[92:95], v[76:79], 0
    v_mfma_f32_16x16x32_bf16 v[100:103], v[96:99], v[80:83], v[100:103]
    s_nop 7
    s_nop 3
    v_cvt_pk_bf16_f32 v6, v100, v101
    v_cvt_pk_bf16_f32 v7, v102, v103
    s_add_u32 s30, s27, 0
    buffer_store_dwordx2 v[6:7], v8, s[4:7], s30 offen offset:160
    s_nop 1
    v_mfma_f32_16x16x32_bf16 v[100:103], v[92:95], v[84:87], 0
    v_mfma_f32_16x16x32_bf16 v[100:103], v[96:99], v[88:91], v[100:103]
    s_nop 7
    s_nop 3
    v_cvt_pk_bf16_f32 v6, v100, v101
    v_cvt_pk_bf16_f32 v7, v102, v103
    s_add_u32 s30, s27, 131072
    buffer_store_dwordx2 v[6:7], v8, s[4:7], s30 offen offset:160
    s_nop 1
    ds_read_b64_tr_b16 v[92:93], v11 offset:192
    ds_read_b64_tr_b16 v[94:95], v11 offset:4544
    ds_read_b64_tr_b16 v[96:97], v11 offset:8896
    ds_read_b64_tr_b16 v[98:99], v11 offset:8896
    s_waitcnt lgkmcnt(0)
    v_mfma_f32_16x16x32_bf16 v[100:103], v[92:95], v[76:79], 0
    v_mfma_f32_16x16x32_bf16 v[100:103], v[96:99], v[80:83], v[100:103]
    s_nop 7
    s_nop 3
    v_cvt_pk_bf16_f32 v6, v100, v101
    v_cvt_pk_bf16_f32 v7, v102, v103
    s_add_u32 s30, s27, 0
    buffer_store_dwordx2 v[6:7], v8, s[4:7], s30 offen offset:192
    s_nop 1
    v_mfma_f32_16x16x32_bf16 v[100:103], v[92:95], v[84:87], 0
    v_mfma_f32_16x16x32_bf16 v[100:103], v[96:99], v[88:91], v[100:103]
    s_nop 7
    s_nop 3
    v_cvt_pk_bf16_f32 v6, v100, v101
    v_cvt_pk_bf16_f32 v7, v102, v103
    s_add_u32 s30, s27, 131072
    buffer_store_dwordx2 v[6:7], v8, s[4:7], s30 offen offset:192
    s_nop 1
    ds_read_b64_tr_b16 v[92:93], v11 offset:224
    ds_read_b64_tr_b16 v[94:95], v11 offset:4576
    ds_read_b64_tr_b16 v[96:97], v11 offset:8928
    ds_read_b64_tr_b16 v[98:99], v11 offset:8928
    s_waitcnt lgkmcnt(0)
    v_mfma_f32_16x16x32_bf16 v[100:103], v[92:95], v[76:79], 0
    v_mfma_f32_16x16x32_bf16 v[100:103], v[96:99], v[80:83], v[100:103]
    s_nop 7
    s_nop 3
    v_cvt_pk_bf16_f32 v6, v100, v101
    v_cvt_pk_bf16_f32 v7, v102, v103
    s_add_u32 s30, s27, 0
    buffer_store_dwordx2 v[6:7], v8, s[4:7], s30 offen offset:224
    s_nop 1
    v_mfma_f32_16x16x32_bf16 v[100:103], v[92:95], v[84:87], 0
    v_mfma_f32_16x16x32_bf16 v[100:103], v[96:99], v[88:91], v[100:103]
    s_nop 7
    s_nop 3
    v_cvt_pk_bf16_f32 v6, v100, v101
    v_cvt_pk_bf16_f32 v7, v102, v103
    s_add_u32 s30, s27, 131072
    buffer_store_dwordx2 v[6:7], v8, s[4:7], s30 offen offset:224
    s_nop 1
attnB_kernel_end:
    s_endpgm
.section .rodata,"a"
.p2align 6
.amdhsa_kernel attnB_kernel
  .amdhsa_next_free_vgpr 108
  .amdhsa_next_free_sgpr 102
  .amdhsa_accum_offset 108
  .amdhsa_group_segment_fixed_size 0
  .amdhsa_kernarg_size 104
  .amdhsa_user_sgpr_count 2
  .amdhsa_user_sgpr_kernarg_segment_ptr 1
  .amdhsa_system_sgpr_workgroup_id_x 1
.end_amdhsa_kernel

.text
.globl gemm2_kernel
.p2align 8
.type gemm2_kernel,@function
gemm2_kernel:
    s_cmp_ge_u32 s2, 256
    s_cbranch_scc1 gemm2_kernel_end
    s_load_dwordx16 s[40:55], s[0:1], 0
    s_load_dwordx8 s[56:63], s[0:1], 64
    s_load_dwordx2 s[64:65], s[0:1], 96
    v_and_b32 v113, 63, v0
    v_lshrrev_b32 v114, 6, v0
    s_nop 1
    v_readfirstlane_b32 s3, v114
    s_waitcnt lgkmcnt(0)
    s_and_b32 s76, s2, 127
    s_lshr_b32 s72, s76, 3
    s_and_b32 s73, s76, 7
    s_lshl_b32 s75, s73, 8
    s_mul_i32 s74, s72, 524288
    s_add_u32 s74, s74, s75
    s_cmp_ge_u32 s2, 128
    s_cbranch_scc1 gemm2_kernel_g2a1
    s_mul_i32 s77, s72, 1048576
    s_add_u32 s77, s77, 67108864
    s_add_u32 s20, s64, s77
    s_addc_u32 s21, s65, 0
    s_add_u32 s22, s56, s75
    s_addc_u32 s23, s57, 0
    s_add_u32 s74, s74, 2048
    s_add_u32 s24, s60, s74
    s_addc_u32 s25, s61, 0
    s_mov_b32 s26, 8192
    s_mov_b32 s29, 64
    s_branch gemm2_kernel_g2d2
gemm2_kernel_g2a1:
    s_mul_i32 s77, s72, 262144
    s_add_u32 s77, s77, 62914560
    s_add_u32 s20, s64, s77
    s_addc_u32 s21, s65, 0
    s_add_u32 s22, s44, s75
    s_addc_u32 s23, s45, 0
    s_add_u32 s24, s60, s74
    s_addc_u32 s25, s61, 0
    s_mov_b32 s26, 2048
    s_mov_b32 s29, 16
gemm2_kernel_g2d2:
    s_mov_b32 s27, 2048
    s_mov_b32 s28, 4096
    s_mov_b32 s4, s20
    s_and_b32 s5, s21, 0xffff
    s_mov_b32 s6, 0x7ffffff0
    s_mov_b32 s7, 0x00020000
    s_mov_b32 s8, s22
    s_and_b32 s9, s23, 0xffff
    s_mov_b32 s10, 0x7ffffff0
    s_mov_b32 s11, 0x00020000
    s_mov_b32 s12, s24
    s_and_b32 s13, s25, 0xffff
    s_mov_b32 s14, 0x7ffffff0
    s_mov_b32 s15, 0x00020000
    s_lshr_b32 s30, s3, 1
    s_and_b32 s31, s3, 1
    v_and_b32 v115, 15, v113
    v_lshrrev_b32 v116, 4, v113
    v_lshrrev_b32 v117, 1, v115
    s_mul_i32 s32, s30, 8192
    v_or_b32 v118, 0, v116
    v_xor_b32 v118, v118, v117
    v_lshlrev_b32 v118, 4, v118
    v_lshl_add_u32 v118, v115, 7, v118
    v_add_u32 v96, s32, v118
    v_add_u32 v98, 32768, v96
    v_or_b32 v118, 4, v116
    v_xor_b32 v118, v118, v117
    v_lshlrev_b32 v118, 4, v118
    v_lshl_add_u32 v118, v115, 7, v118
    v_add_u32 v97, s32, v118
    v_add_u32 v99, 32768, v97
    v_lshrrev_b32 v117, 2, v115
    v_and_b32 v118, 1, v116
    v_lshl_or_b32 v118, v118, 2, v117
    v_lshlrev_b32 v118, 1, v118
    v_lshl_add_u32 v117, v116, 3, v117
    s_mov_b32 s33, 256
    v_mul_lo_u32 v117, v117, s33
    v_and_b32 v115, 3, v113
    v_and_b32 v116, 1, v115
    v_lshl_add_u32 v117, v116, 3, v117
    v_add_u32 v117, 16384, v117
    v_lshrrev_b32 v115, 1, v115
    s_mul_i32 s32, s31, 8
    s_add_u32 s33, s32, 0
    v_or_b32 v116, s33, v115
    v_xor_b32 v116, v116, v118
    v_lshl_add_u32 v100, v116, 4, v117
    v_add_u32 v104, 32768, v100
    s_add_u32 s33, s32, 2
    v_or_b32 v116, s33, v115
    v_xor_b32 v116, v116, v118
    v_lshl_add_u32 v101, v116, 4, v117
    v_add_u32 v105, 32768, v101
    s_add_u32 s33, s32, 4
    v_or_b32 v116, s33, v115
    v_xor_b32 v116, v116, v118
    v_lshl_add_u32 v102, v116, 4, v117
    v_add_u32 v106, 32768, v102
    s_add_u32 s33, s32, 6
    v_or_b32 v116, s33, v115
    v_xor_b32 v116, v116, v118
    v_lshl_add_u32 v103, v116, 4, v117
    v_add_u32 v107, 32768, v103
    v_lshrrev_b32 v115, 3, v113
    v_mul_lo_u32 v115, v115, s26
    v_and_b32 v116, 7, v113
    v_lshrrev_b32 v117, 4, v113
    v_or_b32 v118, 0, v117
    v_xor_b32 v118, v118, v116
    v_lshl_add_u32 v108, v118, 4, v115
    v_or_b32 v118, 4, v117
    v_xor_b32 v118, v118, v116
    v_lshl_add_u32 v109, v118, 4, v115
    v_lshrrev_b32 v115, 4, v113
    v_and_b32 v116, 15, v113
    v_mul_lo_u32 v117, v115, s27
    v_or_b32 v118, 0, v115
    v_lshlrev_b32 v118, 1, v118
    v_xor_b32 v118, v118, v116
    v_lshl_add_u32 v110, v118, 4, v117
    v_or_b32 v118, 4, v115
    v_lshlrev_b32 v118, 1, v118
    v_xor_b32 v118, v118, v116
    v_lshl_add_u32 v111, v118, 4, v117
    v_and_b32 v115, 15, v113
    s_mul_i32 s32, s30, 64
    v_add_u32 v115, s32, v115
    v_mul_lo_u32 v115, v115, s28
    v_lshrrev_b32 v116, 4, v113
    s_mul_i32 s32, s31, 128
    v_lshl_add_u32 v115, v116, 3, v115
    v_add_u32 v112, s32, v115
    s_lshl_b32 s35, s26, 3
    s_mul_i32 s34, s3, 4
    s_mul_i32 s34, s34, s35
    s_mul_i32 s37, s27, 4
    s_mul_i32 s36, s3, 4
    s_mul_i32 s36, s36, s37
    s_lshl_b32 s38, s27, 6
    s_mul_i32 s66, s3, 4096
    s_mul_i32 s67, s3, 4096
    s_add_u32 s67, s67, 16384
    v_mov_b32 v0, 0
    v_mov_b32 v1, 0
    v_mov_b32 v2, 0
    v_mov_b32 v3, 0
    v_mov_b32 v4, 0
    v_mov_b32 v5, 0
    v_mov_b32 v6, 0
    v_mov_b32 v7, 0
    v_mov_b32 v8, 0
    v_mov_b32 v9, 0
    v_mov_b32 v10, 0
    v_mov_b32 v11, 0
    v_mov_b32 v12, 0
    v_mov_b32 v13, 0
    v_mov_b32 v14, 0
    v_mov_b32 v15, 0
    v_mov_b32 v16, 0
    v_mov_b32 v17, 0
    v_mov_b32 v18, 0
    v_mov_b32 v19, 0
    v_mov_b32 v20, 0
    v_mov_b32 v21, 0
    v_mov_b32 v22, 0
    v_mov_b32 v23, 0
    v_mov_b32 v24, 0
    v_mov_b32 v25, 0
    v_mov_b32 v26, 0
    v_mov_b32 v27, 0
    v_mov_b32 v28, 0
    v_mov_b32 v29, 0
    v_mov_b32 v30, 0
    v_mov_b32 v31, 0
    v_mov_b32 v32, 0
    v_mov_b32 v33, 0
    v_mov_b32 v34, 0
    v_mov_b32 v35, 0
    v_mov_b32 v36, 0
    v_mov_b32 v37, 0
    v_mov_b32 v38, 0
    v_mov_b32 v39, 0
    v_mov_b32 v40, 0
    v_mov_b32 v41, 0
    v_mov_b32 v42, 0
    v_mov_b32 v43, 0
    v_mov_b32 v44, 0
    v_mov_b32 v45, 0
    v_mov_b32 v46, 0
    v_mov_b32 v47, 0
    v_mov_b32 v48, 0
    v_mov_b32 v49, 0
    v_mov_b32 v50, 0
    v_mov_b32 v51, 0
    v_mov_b32 v52, 0
    v_mov_b32 v53, 0
    v_mov_b32 v54, 0
    v_mov_b32 v55, 0
    v_mov_b32 v56, 0
    v_mov_b32 v57, 0
    v_mov_b32 v58, 0
    v_mov_b32 v59, 0
    v_mov_b32 v60, 0
    v_mov_b32 v61, 0
    v_mov_b32 v62, 0
    v_mov_b32 v63, 0
    s_nop 4
    s_add_u32 m0, s66, 0
    s_mov_b32 s39, s34
    buffer_load_dwordx4 v108, s[4:7], s39 offen lds
    s_add_u32 m0, s66, 1024
    s_add_u32 s39, s39, s35
    buffer_load_dwordx4 v109, s[4:7], s39 offen lds
    s_add_u32 m0, s66, 2048
    s_add_u32 s39, s39, s35
    buffer_load_dwordx4 v108, s[4:7], s39 offen lds
    s_add_u32 m0, s66, 3072
    s_add_u32 s39, s39, s35
    buffer_load_dwordx4 v109, s[4:7], s39 offen lds
    s_add_u32 m0, s67, 0
    s_mov_b32 s39, s36
    buffer_load_dwordx4 v110, s[8:11], s39 offen lds
    s_add_u32 m0, s67, 1024
    s_add_u32 s39, s39, s37
    buffer_load_dwordx4 v110, s[8:11], s39 offen lds
    s_add_u32 m0, s67, 2048
    s_add_u32 s39, s39, s37
    buffer_load_dwordx4 v111, s[8:11], s39 offen lds
    s_add_u32 m0, s67, 3072
    s_add_u32 s39, s39, s37
    buffer_load_dwordx4 v111, s[8:11], s39 offen lds
    s_add_u32 s34, s34, 128
    s_add_u32 s36, s36, s38
    s_mov_b32 s70, 0
gemm2_kernel_loop3:
    s_waitcnt vmcnt(0)
    s_barrier
    s_add_u32 s71, s70, 1
    s_cmp_ge_u32 s71, s29
    s_cbranch_scc1 gemm2_kernel_skip4
    s_add_u32 m0, s66, 32768
    s_mov_b32 s39, s34
    buffer_load_dwordx4 v108, s[4:7], s39 offen lds
    s_add_u32 m0, s66, 33792
    s_add_u32 s39, s39, s35
    buffer_load_dwordx4 v109, s[4:7], s39 offen lds
    s_add_u32 m0, s66, 34816
    s_add_u32 s39, s39, s35
    buffer_load_dwordx4 v108, s[4:7], s39 offen lds
    s_add_u32 m0, s66, 35840
    s_add_u32 s39, s39, s35
    buffer_load_dwordx4 v109, s[4:7], s39 offen lds
    s_add_u32 m0, s67, 32768
    s_mov_b32 s39, s36
    buffer_load_dwordx4 v110, s[8:11], s39 offen lds
    s_add_u32 m0, s67, 33792
    s_add_u32 s39, s39, s37
    buffer_load_dwordx4 v110, s[8:11], s39 offen lds
    s_add_u32 m0, s67, 34816
    s_add_u32 s39, s39, s37
    buffer_load_dwordx4 v111, s[8:11], s39 offen lds
    s_add_u32 m0, s67, 35840
    s_add_u32 s39, s39, s37
    buffer_load_dwordx4 v111, s[8:11], s39 offen lds
    s_add_u32 s34, s34, 128
    s_add_u32 s36, s36, s38
gemm2_kernel_skip4:
    ds_read_b128 v[64:67], v96 offset:0
    ds_read_b128 v[68:71], v96 offset:2048
    ds_read_b128 v[72:75], v96 offset:4096
    ds_read_b128 v[76:79], v96 offset:6144
    ds_read_b64_tr_b16 v[80:81], v100 offset:0
    ds_read_b64_tr_b16 v[82:83], v100 offset:1024
    ds_read_b64_tr_b16 v[84:85], v101 offset:0
    ds_read_b64_tr_b16 v[86:87], v101 offset:1024
    ds_read_b64_tr_b16 v[88:89], v102 offset:0
    ds_read_b64_tr_b16 v[90:91], v102 offset:1024
    ds_read_b64_tr_b16 v[92:93], v103 offset:0
    ds_read_b64_tr_b16 v[94:95], v103 offset:1024
    s_waitcnt lgkmcnt(0)
    v_mfma_f32_16x16x32_bf16 v[0:3], v[80:83], v[64:67], v[0:3]
    v_mfma_f32_16x16x32_bf16 v[4:7], v[84:87], v[64:67], v[4:7]
    v_mfma_f32_16x16x32_bf16 v[8:11], v[88:91], v[64:67], v[8:11]
    v_mfma_f32_16x16x32_bf16 v[12:15], v[92:95], v[64:67], v[12:15]
    v_mfma_f32_16x16x32_bf16 v[16:19], v[80:83], v[68:71], v[16:19]
    v_mfma_f32_16x16x32_bf16 v[20:23], v[84:87], v[68:71], v[20:23]
    v_mfma_f32_16x16x32_bf16 v[24:27], v[88:91], v[68:71], v[24:27]
    v_mfma_f32_16x16x32_bf16 v[28:31], v[92:95], v[68:71], v[28:31]
    v_mfma_f32_16x16x32_bf16 v[32:35], v[80:83], v[72:75], v[32:35]
    v_mfma_f32_16x16x32_bf16 v[36:39], v[84:87], v[72:75], v[36:39]
    v_mfma_f32_16x16x32_bf16 v[40:43], v[88:91], v[72:75], v[40:43]
    v_mfma_f32_16x16x32_bf16 v[44:47], v[92:95], v[72:75], v[44:47]
    v_mfma_f32_16x16x32_bf16 v[48:51], v[80:83], v[76:79], v[48:51]
    v_mfma_f32_16x16x32_bf16 v[52:55], v[84:87], v[76:79], v[52:55]
    v_mfma_f32_16x16x32_bf16 v[56:59], v[88:91], v[76:79], v[56:59]
    v_mfma_f32_16x16x32_bf16 v[60:63], v[92:95], v[76:79], v[60:63]
    ds_read_b128 v[64:67], v97 offset:0
    ds_read_b128 v[68:71], v97 offset:2048
    ds_read_b128 v[72:75], v97 offset:4096
    ds_read_b128 v[76:79], v97 offset:6144
    ds_read_b64_tr_b16 v[80:81], v100 offset:8192
    ds_read_b64_tr_b16 v[82:83], v100 offset:9216
    ds_read_b64_tr_b16 v[84:85], v101 offset:8192
    ds_read_b64_tr_b16 v[86:87], v101 offset:9216
    ds_read_b64_tr_b16 v[88:89], v102 offset:8192
    ds_read_b64_tr_b16 v[90:91], v102 offset:9216
    ds_read_b64_tr_b16 v[92:93], v103 offset:8192
    ds_read_b64_tr_b16 v[94:95], v103 offset:9216
    s_waitcnt lgkmcnt(0)
    v_mfma_f32_16x16x32_bf16 v[0:3], v[80:83], v[64:67], v[0:3]
    v_mfma_f32_16x16x32_bf16 v[4:7], v[84:87], v[64:67], v[4:7]
    v_mfma_f32_16x16x32_bf16 v[8:11], v[88:91], v[64:67], v[8:11]
    v_mfma_f32_16x16x32_bf16 v[12:15], v[92:95], v[64:67], v[12:15]
    v_mfma_f32_16x16x32_bf16 v[16:19], v[80:83], v[68:71], v[16:19]
    v_mfma_f32_16x16x32_bf16 v[20:23], v[84:87], v[68:71], v[20:23]
    v_mfma_f32_16x16x32_bf16 v[24:27], v[88:91], v[68:71], v[24:27]
    v_mfma_f32_16x16x32_bf16 v[28:31], v[92:95], v[68:71], v[28:31]
    v_mfma_f32_16x16x32_bf16 v[32:35], v[80:83], v[72:75], v[32:35]
    v_mfma_f32_16x16x32_bf16 v[36:39], v[84:87], v[72:75], v[36:39]
    v_mfma_f32_16x16x32_bf16 v[40:43], v[88:91], v[72:75], v[40:43]
    v_mfma_f32_16x16x32_bf16 v[44:47], v[92:95], v[72:75], v[44:47]
    v_mfma_f32_16x16x32_bf16 v[48:51], v[80:83], v[76:79], v[48:51]
    v_mfma_f32_16x16x32_bf16 v[52:55], v[84:87], v[76:79], v[52:55]
    v_mfma_f32_16x16x32_bf16 v[56:59], v[88:91], v[76:79], v[56:59]
    v_mfma_f32_16x16x32_bf16 v[60:63], v[92:95], v[76:79], v[60:63]
    s_waitcnt vmcnt(0)
    s_barrier
    s_add_u32 s71, s70, 2
    s_cmp_ge_u32 s71, s29
    s_cbranch_scc1 gemm2_kernel_skip5
    s_add_u32 m0, s66, 0
    s_mov_b32 s39, s34
    buffer_load_dwordx4 v108, s[4:7], s39 offen lds
    s_add_u32 m0, s66, 1024
    s_add_u32 s39, s39, s35
    buffer_load_dwordx4 v109, s[4:7], s39 offen lds
    s_add_u32 m0, s66, 2048
    s_add_u32 s39, s39, s35
    buffer_load_dwordx4 v108, s[4:7], s39 offen lds
    s_add_u32 m0, s66, 3072
    s_add_u32 s39, s39, s35
    buffer_load_dwordx4 v109, s[4:7], s39 offen lds
    s_add_u32 m0, s67, 0
    s_mov_b32 s39, s36
    buffer_load_dwordx4 v110, s[8:11], s39 offen lds
    s_add_u32 m0, s67, 1024
    s_add_u32 s39, s39, s37
    buffer_load_dwordx4 v110, s[8:11], s39 offen lds
    s_add_u32 m0, s67, 2048
    s_add_u32 s39, s39, s37
    buffer_load_dwordx4 v111, s[8:11], s39 offen lds
    s_add_u32 m0, s67, 3072
    s_add_u32 s39, s39, s37
    buffer_load_dwordx4 v111, s[8:11], s39 offen lds
    s_add_u32 s34, s34, 128
    s_add_u32 s36, s36, s38
gemm2_kernel_skip5:
    ds_read_b128 v[64:67], v98 offset:0
    ds_read_b128 v[68:71], v98 offset:2048
    ds_read_b128 v[72:75], v98 offset:4096
    ds_read_b128 v[76:79], v98 offset:6144
    ds_read_b64_tr_b16 v[80:81], v104 offset:0
    ds_read_b64_tr_b16 v[82:83], v104 offset:1024
    ds_read_b64_tr_b16 v[84:85], v105 offset:0
    ds_read_b64_tr_b16 v[86:87], v105 offset:1024
    ds_read_b64_tr_b16 v[88:89], v106 offset:0
    ds_read_b64_tr_b16 v[90:91], v106 offset:1024
    ds_read_b64_tr_b16 v[92:93], v107 offset:0
    ds_read_b64_tr_b16 v[94:95], v107 offset:1024
    s_waitcnt lgkmcnt(0)
    v_mfma_f32_16x16x32_bf16 v[0:3], v[80:83], v[64:67], v[0:3]
    v_mfma_f32_16x16x32_bf16 v[4:7], v[84:87], v[64:67], v[4:7]
    v_mfma_f32_16x16x32_bf16 v[8:11], v[88:91], v[64:67], v[8:11]
    v_mfma_f32_16x16x32_bf16 v[12:15], v[92:95], v[64:67], v[12:15]
    v_mfma_f32_16x16x32_bf16 v[16:19], v[80:83], v[68:71], v[16:19]
    v_mfma_f32_16x16x32_bf16 v[20:23], v[84:87], v[68:71], v[20:23]
    v_mfma_f32_16x16x32_bf16 v[24:27], v[88:91], v[68:71], v[24:27]
    v_mfma_f32_16x16x32_bf16 v[28:31], v[92:95], v[68:71], v[28:31]
    v_mfma_f32_16x16x32_bf16 v[32:35], v[80:83], v[72:75], v[32:35]
    v_mfma_f32_16x16x32_bf16 v[36:39], v[84:87], v[72:75], v[36:39]
    v_mfma_f32_16x16x32_bf16 v[40:43], v[88:91], v[72:75], v[40:43]
    v_mfma_f32_16x16x32_bf16 v[44:47], v[92:95], v[72:75], v[44:47]
    v_mfma_f32_16x16x32_bf16 v[48:51], v[80:83], v[76:79], v[48:51]
    v_mfma_f32_16x16x32_bf16 v[52:55], v[84:87], v[76:79], v[52:55]
    v_mfma_f32_16x16x32_bf16 v[56:59], v[88:91], v[76:79], v[56:59]
    v_mfma_f32_16x16x32_bf16 v[60:63], v[92:95], v[76:79], v[60:63]
    ds_read_b128 v[64:67], v99 offset:0
    ds_read_b128 v[68:71], v99 offset:2048
    ds_read_b128 v[72:75], v99 offset:4096
    ds_read_b128 v[76:79], v99 offset:6144
    ds_read_b64_tr_b16 v[80:81], v104 offset:8192
    ds_read_b64_tr_b16 v[82:83], v104 offset:9216
    ds_read_b64_tr_b16 v[84:85], v105 offset:8192
    ds_read_b64_tr_b16 v[86:87], v105 offset:9216
    ds_read_b64_tr_b16 v[88:89], v106 offset:8192
    ds_read_b64_tr_b16 v[90:91], v106 offset:9216
    ds_read_b64_tr_b16 v[92:93], v107 offset:8192
    ds_read_b64_tr_b16 v[94:95], v107 offset:9216
    s_waitcnt lgkmcnt(0)
    v_mfma_f32_16x16x32_bf16 v[0:3], v[80:83], v[64:67], v[0:3]
    v_mfma_f32_16x16x32_bf16 v[4:7], v[84:87], v[64:67], v[4:7]
    v_mfma_f32_16x16x32_bf16 v[8:11], v[88:91], v[64:67], v[8:11]
    v_mfma_f32_16x16x32_bf16 v[12:15], v[92:95], v[64:67], v[12:15]
    v_mfma_f32_16x16x32_bf16 v[16:19], v[80:83], v[68:71], v[16:19]
    v_mfma_f32_16x16x32_bf16 v[20:23], v[84:87], v[68:71], v[20:23]
    v_mfma_f32_16x16x32_bf16 v[24:27], v[88:91], v[68:71], v[24:27]
    v_mfma_f32_16x16x32_bf16 v[28:31], v[92:95], v[68:71], v[28:31]
    v_mfma_f32_16x16x32_bf16 v[32:35], v[80:83], v[72:75], v[32:35]
    v_mfma_f32_16x16x32_bf16 v[36:39], v[84:87], v[72:75], v[36:39]
    v_mfma_f32_16x16x32_bf16 v[40:43], v[88:91], v[72:75], v[40:43]
    v_mfma_f32_16x16x32_bf16 v[44:47], v[92:95], v[72:75], v[44:47]
    v_mfma_f32_16x16x32_bf16 v[48:51], v[80:83], v[76:79], v[48:51]
    v_mfma_f32_16x16x32_bf16 v[52:55], v[84:87], v[76:79], v[52:55]
    v_mfma_f32_16x16x32_bf16 v[56:59], v[88:91], v[76:79], v[56:59]
    v_mfma_f32_16x16x32_bf16 v[60:63], v[92:95], v[76:79], v[60:63]
    s_add_u32 s70, s70, 2
    s_cmp_lt_u32 s70, s29
    s_cbranch_scc1 gemm2_kernel_loop3
    s_nop 7
    s_nop 7
    s_lshl_b32 s35, s28, 4
    s_mov_b32 s39, 0
    v_cvt_pk_bf16_f32 v0, v0, v1
    v_cvt_pk_bf16_f32 v1, v2, v3
    buffer_store_dwordx2 v[0:1], v112, s[12:15], s39 offen offset:0
    v_cvt_pk_bf16_f32 v4, v4, v5
    v_cvt_pk_bf16_f32 v5, v6, v7
    buffer_store_dwordx2 v[4:5], v112, s[12:15], s39 offen offset:32
    v_cvt_pk_bf16_f32 v8, v8, v9
    v_cvt_pk_bf16_f32 v9, v10, v11
    buffer_store_dwordx2 v[8:9], v112, s[12:15], s39 offen offset:64
    v_cvt_pk_bf16_f32 v12, v12, v13
    v_cvt_pk_bf16_f32 v13, v14, v15
    buffer_store_dwordx2 v[12:13], v112, s[12:15], s39 offen offset:96
    s_add_u32 s39, s39, s35
    v_cvt_pk_bf16_f32 v16, v16, v17
    v_cvt_pk_bf16_f32 v17, v18, v19
    buffer_store_dwordx2 v[16:17], v112, s[12:15], s39 offen offset:0
    v_cvt_pk_bf16_f32 v20, v20, v21
    v_cvt_pk_bf16_f32 v21, v22, v23
    buffer_store_dwordx2 v[20:21], v112, s[12:15], s39 offen offset:32
    v_cvt_pk_bf16_f32 v24, v24, v25
    v_cvt_pk_bf16_f32 v25, v26, v27
    buffer_store_dwordx2 v[24:25], v112, s[12:15], s39 offen offset:64
    v_cvt_pk_bf16_f32 v28, v28, v29
    v_cvt_pk_bf16_f32 v29, v30, v31
    buffer_store_dwordx2 v[28:29], v112, s[12:15], s39 offen offset:96
    s_add_u32 s39, s39, s35
    v_cvt_pk_bf16_f32 v32, v32, v33
    v_cvt_pk_bf16_f32 v33, v34, v35
    buffer_store_dwordx2 v[32:33], v112, s[12:15], s39 offen offset:0
    v_cvt_pk_bf16_f32 v36, v36, v37
    v_cvt_pk_bf16_f32 v37, v38, v39
    buffer_store_dwordx2 v[36:37], v112, s[12:15], s39 offen offset:32
    v_cvt_pk_bf16_f32 v40, v40, v41
    v_cvt_pk_bf16_f32 v41, v42, v43
    buffer_store_dwordx2 v[40:41], v112, s[12:15], s39 offen offset:64
    v_cvt_pk_bf16_f32 v44, v44, v45
    v_cvt_pk_bf16_f32 v45, v46, v47
    buffer_store_dwordx2 v[44:45], v112, s[12:15], s39 offen offset:96
    s_add_u32 s39, s39, s35
    v_cvt_pk_bf16_f32 v48, v48, v49
    v_cvt_pk_bf16_f32 v49, v50, v51
    buffer_store_dwordx2 v[48:49], v112, s[12:15], s39 offen offset:0
    v_cvt_pk_bf16_f32 v52, v52, v53
    v_cvt_pk_bf16_f32 v53, v54, v55
    buffer_store_dwordx2 v[52:53], v112, s[12:15], s39 offen offset:32
    v_cvt_pk_bf16_f32 v56, v56, v57
    v_cvt_pk_bf16_f32 v57, v58, v59
    buffer_store_dwordx2 v[56:57], v112, s[12:15], s39 offen offset:64
    v_cvt_pk_bf16_f32 v60, v60, v61
    v_cvt_pk_bf16_f32 v61, v62, v63
    buffer_store_dwordx2 v[60:61], v112, s[12:15], s39 offen offset:96
    s_add_u32 s39, s39, s35
gemm2_kernel_end:
    s_endpgm
.section .rodata,"a"
.p2align 6
.amdhsa_kernel gemm2_kernel
  .amdhsa_next_free_vgpr 121
  .amdhsa_next_free_sgpr 102
  .amdhsa_accum_offset 124
  .amdhsa_group_segment_fixed_size 0
  .amdhsa_kernarg_size 104
  .amdhsa_user_sgpr_count 2
  .amdhsa_user_sgpr_kernarg_segment_ptr 1
  .amdhsa_system_sgpr_workgroup_id_x 1
.end_amdhsa_kernel
```
